```python
import torch

def _softmax(x, axis=-1):
    return torch.softmax(x, dim=axis)
def _gelu(x):
    return torch.nn.functional.gelu(x, approximate="tanh")
def _silu(x):
    return torch.nn.functional.silu(x)
def _sigmoid(x):
    return torch.sigmoid(x)
def _layernorm(x, axis=-1, eps=1e-5):
    m = x.mean(dim=axis, keepdim=True)
    v = x.var(dim=axis, keepdim=True, unbiased=False)
    return (x - m) / torch.sqrt(v + eps)
def _scatter_add(tgt, idx, src, axis=0):
    return tgt.clone().index_add_(axis, idx, src)
def _segment_sum(src, seg, n):
    out = torch.zeros((n,) + src.shape[1:], dtype=src.dtype)
    return out.index_add_(0, seg, src)
def _pad(x, pw):
    flat = tuple(v for pair in reversed(pw) for v in pair)
    return torch.nn.functional.pad(x, flat)

kernel_name = 'recurrent_scan__sliding_block_cached__glu_gated_glu__decode'

def setup_inputs():

    _w = (lambda a: (lambda t: t.to(torch.bfloat16) if t.is_floating_point() else t)(torch.as_tensor(a)))
    def _A_setup():
        B, Sq, D = 1, 1, 1024
        Hq, Hkv, Sk, Dh = 32, 4, 65536, 128
        assert Hq % Hkv == 0, (Hq, Hkv)
        return {
            "x": _w((lambda *s: torch.randn(*s, dtype=torch.bfloat16) * 0.05)(B, Sq, D)),
            "k_cache": _w((lambda *s: torch.randn(*s, dtype=torch.bfloat16) * 1.6)(B, Hkv, Sk, Dh)),
            "v_cache": _w((lambda *s: torch.randn(*s, dtype=torch.bfloat16) * 0.2)(B, Hkv, Sk, Dh)),
            "wq": _w((lambda *s: torch.randn(*s, dtype=torch.bfloat16) * 1.6)(D, Hq * Dh) * (D ** -0.5)),
            "wo": _w((lambda *s: torch.randn(*s, dtype=torch.bfloat16) * 0.2)(Hq * Dh, D) * ((Hq * Dh) ** -0.5)),
        }
    _A_in = _A_setup()

    def _B_setup():
        B, S, D, F = 1, 1, 1024, 3584
        return {
            "x": _w((lambda *s: torch.randn(*s, dtype=torch.bfloat16) * 0.05)(B, S, D)),
            "w_gate": _w((lambda *s: torch.randn(*s, dtype=torch.bfloat16) * 0.2)(D, F)),
            "w_up": _w((lambda *s: torch.randn(*s, dtype=torch.bfloat16) * 0.1)(D, F)),
            "w_down": _w((lambda *s: torch.randn(*s, dtype=torch.bfloat16) * 0.1)(F, D)),
        }
    _B_in = _B_setup()

    return {
        "A_x": _A_in["x"],
        "A_k_cache": _A_in["k_cache"],
        "A_v_cache": _A_in["v_cache"],
        "A_wq": _A_in["wq"],
        "A_wo": _A_in["wo"],
        "B_x": _B_in["x"],
        "B_w_gate": _B_in["w_gate"],
        "B_w_up": _B_in["w_up"],
        "B_w_down": _B_in["w_down"],
    }

def reference(A_x, A_k_cache, A_v_cache, A_wq, A_wo, B_x, B_w_gate, B_w_up, B_w_down):
    def _A_ref(x, k_cache, v_cache, wq, wo):
        B, Sq, D = x.shape
        Hq, Dh = 32, 128
        Hkv, Sk = k_cache.shape[1], k_cache.shape[2]
        W = min(4096, max(256, Sk // 4))
        rep = Hq // Hkv
        q = (lambda x, *d: x.permute(*d))((x @ wq).reshape(B, Sq, Hq, Dh), 0, 2, 1, 3)
        k = (lambda x, n, axis: torch.repeat_interleave(x, n, dim=axis))(k_cache[:, :, Sk - W:, :], rep, axis=1)
        v = (lambda x, n, axis: torch.repeat_interleave(x, n, dim=axis))(v_cache[:, :, Sk - W:, :], rep, axis=1)
        scores = torch.einsum("bhqd,bhkd->bhqk", q, k) * (Dh ** -0.5)
        p = _softmax(scores, axis=-1)
        o = torch.einsum("bhqk,bhkd->bhqd", p, v)
        return (lambda x, *d: x.permute(*d))(o, 0, 2, 1, 3).reshape(B, Sq, Hq * Dh) @ wo

    def _B_ref(x, w_gate, w_up, w_down):
        g = torch.einsum("bsd,df->bsf", x, w_gate)
        u = torch.einsum("bsd,df->bsf", x, w_up)
        h = _sigmoid(g) * u
        return torch.einsum("bsf,fd->bsd", h, w_down)

    x = A_x
    xn = _layernorm(x, axis=-1)
    s = _A_ref(xn, A_k_cache, A_v_cache, A_wq, A_wo)
    g = _silu(_B_ref(xn, B_w_gate, B_w_up, B_w_down))
    return x + s * g
```

```asm
; @launch grid=(256,1,1) block=(512,1,1) lds=133888
.amdgcn_target "amdgcn-amd-amdhsa--gfx950"
.text
.globl recurrent_scan__sliding_block_cached__glu_gated_glu__decode_kernel
.p2align 12
.fill 832, 4, 0xbf810000
.p2align 8
.type recurrent_scan__sliding_block_cached__glu_gated_glu__decode_kernel,@function
recurrent_scan__sliding_block_cached__glu_gated_glu__decode_kernel:
s_load_dwordx16 s[4:19], s[0:1], 0
s_load_dwordx8 s[20:27], s[0:1], 64
s_cmpk_ge_u32 s2, 0x100
s_cbranch_scc1 L_end
v_lshrrev_b32 v1, 6, v0
v_and_b32 v0, 63, v0
v_readfirstlane_b32 s3, v1
s_lshr_b32 s37, s2, 6
s_and_b32 s42, s2, 7
s_bfe_u32 s41, s2, 0x30003
s_lshl_b32 s38, s42, 3
s_add_u32 s38, s38, s41
s_sub_u32 s39, s38, s42
s_mov_b32 s100, 400000
s_mul_i32 s101, s42, 102400
s_add_u32 s101, s101, 770048
s_mov_b32 s47, 0x20000
s_mov_b32 s30, 2408448
s_mov_b32 s31, 0x20000
v_lshrrev_b32 v2, 3, v0
v_and_b32 v3, 7, v0
v_lshlrev_b32 v3, 4, v3
v_mov_b32 v6, 0xff
v_mov_b32 v7, 0
s_cmp_eq_u32 s37, 3
s_cbranch_scc1 L_A
s_cmp_eq_u32 s3, 0
s_cbranch_scc1 L_S
s_cmp_eq_u32 s3, 7
s_cbranch_scc0 L_Cbar
s_getpc_b64 s[66:67]
L_pc:
s_lshr_b32 s65, s2, 3
s_cmp_ge_u32 s65, (L_codeend - L_pc) / 1024
s_cbranch_scc1 L_Cbar
s_lshl_b32 s65, s65, 10
s_add_u32 s66, s66, s65
s_addc_u32 s67, s67, 0
v_lshlrev_b32 v20, 4, v0
v_mov_b32 v21, s67
v_add_co_u32 v20, vcc, s66, v20
s_nop 1
v_addc_co_u32 v21, vcc, 0, v21, vcc
global_load_dwordx4 v[64:67], v[20:21], off
L_Cbar:
s_mul_i32 s64, s37, 7
s_add_u32 s64, s64, s41
s_lshr_b32 s65, s41, 2
s_sub_u32 s64, s64, s65
s_cmp_eq_u32 s41, 3
s_cselect_b32 s64, 100, s64
s_mul_i32 s64, s64, 7
s_add_u32 s64, s64, s3
s_sub_u32 s64, s64, 1
s_lshr_b32 s65, s42, 1
s_lshl_b32 s65, s65, 24
s_and_b32 s66, s42, 1
s_lshl_b32 s66, s66, 19
s_add_u32 s65, s65, s66
s_add_u32 s65, s65, 15728640
s_mov_b32 s50, 67108864
s_mov_b32 s51, 0x20000
v_lshlrev_b32 v4, 4, v0
s_waitcnt lgkmcnt(0)
s_mov_b32 s48, s8
s_mov_b32 s49, s9
s_add_u32 s64, s64, 71
s_barrier
s_cmp_ge_u32 s64, 512
s_cbranch_scc1 L_C
L_V0:
s_bfe_u32 s66, s64, 0x30003
s_lshr_b32 s67, s64, 6
s_and_b32 s68, s64, 7
s_and_b32 s69, s66, 1
s_lshl_b32 s69, s69, 2
s_xor_b32 s67, s67, s69
s_lshl_b32 s66, s66, 16
s_lshl_b32 s67, s67, 13
s_lshl_b32 s68, s68, 10
s_add_u32 s66, s66, s67
s_add_u32 s66, s66, s68
s_add_u32 s66, s66, s65
s_waitcnt vmcnt(0)
buffer_load_dwordx4 v[64:67], v4, s[48:51], s66 offen
s_add_u32 s64, s64, 147
s_cmp_lt_u32 s64, 512
s_cbranch_scc1 L_V0
s_branch L_C
L_A:
s_lshr_b32 s40, s38, 4
s_and_b32 s43, s38, 15
s_lshl_b32 s64, s40, 24
s_lshl_b32 s65, s43, 16
s_add_u32 s64, s64, s65
s_lshl_b32 s66, s3, 13
s_lshl_b32 s65, s3, 10
s_add_u32 s64, s64, s65
s_add_u32 s64, s64, 15728640
s_and_b32 s65, s43, 1
s_lshl_b32 s65, s65, 15
s_add_u32 s64, s64, s65
s_xor_b32 s65, s64, 0x8000
s_add_u32 s82, s64, 7168
s_add_u32 s83, s65, 7168
s_add_u32 s84, s64, 14336
s_add_u32 s85, s65, 14336
s_add_u32 s86, s64, 21504
s_add_u32 s87, s65, 21504
v_lshrrev_b32 v9, 4, v0
v_and_b32 v8, 15, v0
v_lshlrev_b32 v4, 1, v9
v_xor_b32 v3, v8, v4
v_lshlrev_b32 v3, 4, v3
v_lshl_add_u32 v3, v9, 8, v3
v_xor_b32 v4, 0x80, v3
s_mov_b32 s46, 67108864
s_mov_b32 s50, 67108864
s_mov_b32 s51, 0x20000
s_mov_b32 m0, s66
s_waitcnt lgkmcnt(0)
s_mov_b32 s44, s6
s_mov_b32 s45, s7
s_mov_b32 s48, s8
s_mov_b32 s49, s9
buffer_load_dwordx4 v3, s[44:47], s64 offen offset:0 nt lds
buffer_load_dwordx4 v4, s[44:47], s82 offen offset:1024 nt lds
buffer_load_dwordx4 v3, s[44:47], s84 offen offset:2048 nt lds
buffer_load_dwordx4 v4, s[44:47], s86 offen offset:3072 nt lds
s_add_u32 m0, s66, 4096
s_waitcnt vmcnt(3)
buffer_load_dwordx4 v3, s[44:47], s65 offen offset:0 nt lds
s_waitcnt vmcnt(3)
buffer_load_dwordx4 v4, s[44:47], s83 offen offset:1024 nt lds
s_waitcnt vmcnt(3)
buffer_load_dwordx4 v3, s[44:47], s85 offen offset:2048 nt lds
s_waitcnt vmcnt(3)
buffer_load_dwordx4 v4, s[44:47], s87 offen offset:3072 nt lds
s_branch L_A2
L_S:
s_setprio 2
v_lshl_add_u32 v1, v2, 13, v3
s_mul_i32 s64, s37, 2818048
s_lshl_b32 s65, s38, 7
s_add_u32 s64, s64, s65
s_mov_b32 s46, 8388608
s_mov_b32 s65, 0x10000
v_lshlrev_b32 v4, 5, v0
s_mul_i32 s66, s37, 688
v_lshlrev_b32 v59, 4, v0
v_add_u32 v5, s66, v59
s_mov_b32 s50, 2048
s_mov_b32 s51, 0x20000
s_waitcnt lgkmcnt(0)
s_mov_b32 s48, s4
s_mov_b32 s49, s5
s_mov_b32 s44, s10
s_mov_b32 s45, s11
buffer_load_dwordx4 v[16:19], v4, s[48:51], 0 offen
buffer_load_dwordx4 v[20:23], v4, s[48:51], 0 offen offset:16
buffer_load_dwordx4 v[48:51], v5, s[48:51], 0 offen
buffer_load_dwordx4 v[68:71], v1, s[44:47], s64 offen nt
s_add_u32 s64, s64, s65
buffer_load_dwordx4 v[72:75], v1, s[44:47], s64 offen nt
s_add_u32 s64, s64, s65
buffer_load_dwordx4 v[76:79], v1, s[44:47], s64 offen nt
s_add_u32 s64, s64, s65
buffer_load_dwordx4 v[80:83], v1, s[44:47], s64 offen nt
s_add_u32 s64, s64, s65
buffer_load_dwordx4 v[84:87], v1, s[44:47], s64 offen nt
s_add_u32 s64, s64, s65
buffer_load_dwordx4 v[88:91], v1, s[44:47], s64 offen nt
s_add_u32 s64, s64, s65
buffer_load_dwordx4 v[92:95], v1, s[44:47], s64 offen nt
s_add_u32 s64, s64, s65
buffer_load_dwordx4 v[96:99], v1, s[44:47], s64 offen nt
s_add_u32 s64, s64, s65
buffer_load_dwordx4 v[100:103], v1, s[44:47], s64 offen nt
s_add_u32 s64, s64, s65
buffer_load_dwordx4 v[104:107], v1, s[44:47], s64 offen nt
s_add_u32 s64, s64, s65
buffer_load_dwordx4 v[108:111], v1, s[44:47], s64 offen nt
s_add_u32 s64, s64, s65
buffer_load_dwordx4 v[112:115], v1, s[44:47], s64 offen nt
s_add_u32 s64, s64, s65
buffer_load_dwordx4 v[116:119], v1, s[44:47], s64 offen nt
s_add_u32 s64, s64, s65
buffer_load_dwordx4 v[120:123], v1, s[44:47], s64 offen nt
s_add_u32 s64, s64, s65
buffer_load_dwordx4 v[124:127], v1, s[44:47], s64 offen nt
s_add_u32 s64, s64, s65
buffer_load_dwordx4 v[128:131], v1, s[44:47], s64 offen nt
s_add_u32 s64, s64, s65
buffer_load_dwordx4 v[132:135], v1, s[44:47], s64 offen nt
s_add_u32 s64, s64, s65
buffer_load_dwordx4 v[136:139], v1, s[44:47], s64 offen nt
s_add_u32 s64, s64, s65
buffer_load_dwordx4 v[140:143], v1, s[44:47], s64 offen nt
s_add_u32 s64, s64, s65
buffer_load_dwordx4 v[144:147], v1, s[44:47], s64 offen nt
s_add_u32 s64, s64, s65
buffer_load_dwordx4 v[148:151], v1, s[44:47], s64 offen nt
s_add_u32 s64, s64, s65
buffer_load_dwordx4 v[152:155], v1, s[44:47], s64 offen nt
s_add_u32 s64, s64, s65
buffer_load_dwordx4 v[156:159], v1, s[44:47], s64 offen nt
s_add_u32 s64, s64, s65
buffer_load_dwordx4 v[160:163], v1, s[44:47], s64 offen nt
s_add_u32 s64, s64, s65
ds_write_b32 v7, v7 offset:1024
s_waitcnt lgkmcnt(0)
s_barrier
v_mul_u32_u24 v4, 96, v2
v_and_b32 v5, 1, v0
v_cmp_eq_u32 vcc, 1, v5
v_mov_b32 v24, 0x0c0c0100
v_mov_b32 v25, 0x01000c0c
v_mov_b32 v26, 0x0c0c0302
v_mov_b32 v27, 0x03020c0c
v_cndmask_b32 v24, v24, v25, vcc
v_cndmask_b32 v26, v26, v27, vcc
v_bfe_u32 v5, v0, 1, 2
v_mov_b32 v25, 0x0c0c0c0c
v_cmp_eq_u32 vcc, 0, v5
s_nop 1
v_cndmask_b32 v8, v25, v24, vcc
v_cndmask_b32 v12, v25, v26, vcc
v_cmp_eq_u32 vcc, 1, v5
s_nop 1
v_cndmask_b32 v9, v25, v24, vcc
v_cndmask_b32 v13, v25, v26, vcc
v_cmp_eq_u32 vcc, 2, v5
s_nop 1
v_cndmask_b32 v10, v25, v24, vcc
v_cndmask_b32 v14, v25, v26, vcc
v_cmp_eq_u32 vcc, 3, v5
s_nop 1
v_cndmask_b32 v11, v25, v24, vcc
v_cndmask_b32 v15, v25, v26, vcc
s_mov_b32 s71, 0x3f803f80
v_lshlrev_b32 v59, 1, v0
s_waitcnt vmcnt(24)
L_TS0:
v_dot2_f32_bf16 v64, v16, s71, 0
v_dot2_f32_bf16 v65, v17, s71, 0
v_dot2_f32_bf16 v64, v18, s71, v64
v_dot2_f32_bf16 v65, v19, s71, v65
v_dot2_f32_bf16 v64, v20, s71, v64
v_dot2_f32_bf16 v65, v21, s71, v65
v_dot2_f32_bf16 v64, v22, s71, v64
v_dot2_f32_bf16 v65, v23, s71, v65
v_lshlrev_b32 v24, 16, v16
v_and_b32 v25, 0xffff0000, v16
v_lshlrev_b32 v26, 16, v17
v_add_f32 v64, v64, v65
v_and_b32 v27, 0xffff0000, v17
v_lshlrev_b32 v28, 16, v18
v_add_f32_dpp v64, v64, v64 row_ror:8 row_mask:0xf bank_mask:0xf
v_and_b32 v29, 0xffff0000, v18
v_lshlrev_b32 v30, 16, v19
v_add_f32_dpp v64, v64, v64 row_ror:4 row_mask:0xf bank_mask:0xf
v_and_b32 v31, 0xffff0000, v19
v_lshlrev_b32 v32, 16, v20
v_add_f32_dpp v64, v64, v64 row_ror:2 row_mask:0xf bank_mask:0xf
v_and_b32 v33, 0xffff0000, v20
v_lshlrev_b32 v34, 16, v21
v_add_f32_dpp v64, v64, v64 row_ror:1 row_mask:0xf bank_mask:0xf
v_mov_b32 v65, v64
v_and_b32 v35, 0xffff0000, v21
v_lshlrev_b32 v36, 16, v22
v_permlane16_swap_b32 v64, v65
v_add_f32 v64, v64, v65
v_mov_b32 v65, v64
v_and_b32 v37, 0xffff0000, v22
v_lshlrev_b32 v38, 16, v23
v_and_b32 v39, 0xffff0000, v23
v_permlane32_swap_b32 v64, v65
v_add_f32 v64, v64, v65
v_mul_f32 v64, 0x3a800000, v64
v_pk_add_f32 v[24:25], v[24:25], v[64:65] op_sel_hi:[1,0] neg_lo:[0,1] neg_hi:[0,1]
v_pk_add_f32 v[26:27], v[26:27], v[64:65] op_sel_hi:[1,0] neg_lo:[0,1] neg_hi:[0,1]
v_pk_add_f32 v[28:29], v[28:29], v[64:65] op_sel_hi:[1,0] neg_lo:[0,1] neg_hi:[0,1]
v_pk_add_f32 v[30:31], v[30:31], v[64:65] op_sel_hi:[1,0] neg_lo:[0,1] neg_hi:[0,1]
v_pk_add_f32 v[32:33], v[32:33], v[64:65] op_sel_hi:[1,0] neg_lo:[0,1] neg_hi:[0,1]
v_pk_add_f32 v[34:35], v[34:35], v[64:65] op_sel_hi:[1,0] neg_lo:[0,1] neg_hi:[0,1]
v_pk_add_f32 v[36:37], v[36:37], v[64:65] op_sel_hi:[1,0] neg_lo:[0,1] neg_hi:[0,1]
v_pk_add_f32 v[38:39], v[38:39], v[64:65] op_sel_hi:[1,0] neg_lo:[0,1] neg_hi:[0,1]
v_pk_mul_f32 v[66:67], v[24:25], v[24:25]
v_pk_mul_f32 v[44:45], v[26:27], v[26:27]
v_pk_fma_f32 v[66:67], v[28:29], v[28:29], v[66:67]
v_pk_fma_f32 v[44:45], v[30:31], v[30:31], v[44:45]
v_pk_fma_f32 v[66:67], v[32:33], v[32:33], v[66:67]
v_pk_fma_f32 v[44:45], v[34:35], v[34:35], v[44:45]
v_pk_fma_f32 v[66:67], v[36:37], v[36:37], v[66:67]
v_pk_fma_f32 v[44:45], v[38:39], v[38:39], v[44:45]
v_pk_add_f32 v[66:67], v[66:67], v[44:45]
v_add_f32 v66, v66, v67
v_cvt_pk_bf16_f32 v64, v64, v64
v_and_b32 v64, 0xffff0000, v64
v_add_f32_dpp v66, v66, v66 row_ror:8 row_mask:0xf bank_mask:0xf
v_lshlrev_b32 v24, 16, v48
v_and_b32 v25, 0xffff0000, v48
v_add_f32_dpp v66, v66, v66 row_ror:4 row_mask:0xf bank_mask:0xf
v_lshlrev_b32 v26, 16, v49
v_and_b32 v27, 0xffff0000, v49
v_add_f32_dpp v66, v66, v66 row_ror:2 row_mask:0xf bank_mask:0xf
v_lshlrev_b32 v28, 16, v50
v_and_b32 v29, 0xffff0000, v50
v_add_f32_dpp v66, v66, v66 row_ror:1 row_mask:0xf bank_mask:0xf
v_mov_b32 v67, v66
v_lshlrev_b32 v30, 16, v51
v_and_b32 v31, 0xffff0000, v51
v_permlane16_swap_b32 v66, v67
v_add_f32 v66, v66, v67
v_mov_b32 v67, v66
v_pk_add_f32 v[24:25], v[24:25], v[64:65] op_sel_hi:[1,0] neg_lo:[0,1] neg_hi:[0,1]
v_pk_add_f32 v[26:27], v[26:27], v[64:65] op_sel_hi:[1,0] neg_lo:[0,1] neg_hi:[0,1]
v_permlane32_swap_b32 v66, v67
v_add_f32 v66, v66, v67
v_mul_f32 v66, 0x3a800000, v66
v_cvt_pk_bf16_f32 v66, v66, v66
v_and_b32 v66, 0xffff0000, v66
v_add_f32 v66, 0x3727c5ac, v66
v_cvt_pk_bf16_f32 v66, v66, v66
v_and_b32 v66, 0xffff0000, v66
v_sqrt_f32 v66, v66
v_pk_add_f32 v[28:29], v[28:29], v[64:65] op_sel_hi:[1,0] neg_lo:[0,1] neg_hi:[0,1]
v_cvt_pk_bf16_f32 v66, v66, v66
v_and_b32 v66, 0xffff0000, v66
v_rcp_f32 v66, v66
v_pk_add_f32 v[30:31], v[30:31], v[64:65] op_sel_hi:[1,0] neg_lo:[0,1] neg_hi:[0,1]
v_cvt_pk_bf16_f32 v48, v24, v25
v_cvt_pk_bf16_f32 v49, v26, v27
v_cvt_pk_bf16_f32 v50, v28, v29
v_cvt_pk_bf16_f32 v51, v30, v31
v_lshlrev_b32 v24, 16, v48
v_and_b32 v25, 0xffff0000, v48
v_lshlrev_b32 v26, 16, v49
v_and_b32 v27, 0xffff0000, v49
v_lshlrev_b32 v28, 16, v50
v_and_b32 v29, 0xffff0000, v50
v_lshlrev_b32 v30, 16, v51
v_and_b32 v31, 0xffff0000, v51
v_pk_mul_f32 v[24:25], v[24:25], v[66:67] op_sel_hi:[1,0]
v_pk_mul_f32 v[26:27], v[26:27], v[66:67] op_sel_hi:[1,0]
v_pk_mul_f32 v[28:29], v[28:29], v[66:67] op_sel_hi:[1,0]
v_pk_mul_f32 v[30:31], v[30:31], v[66:67] op_sel_hi:[1,0]
v_cvt_pk_bf16_f32 v48, v24, v25
v_cvt_pk_bf16_f32 v49, v26, v27
v_cvt_pk_bf16_f32 v50, v28, v29
v_cvt_pk_bf16_f32 v51, v30, v31
s_mov_b32 exec_hi, 0xffff
ds_write_b16 v59, v48 offset:0
ds_write_b16_d16_hi v59, v48 offset:96
ds_write_b16 v59, v49 offset:192
ds_write_b16_d16_hi v59, v49 offset:288
ds_write_b16 v59, v50 offset:384
ds_write_b16_d16_hi v59, v50 offset:480
ds_write_b16 v59, v51 offset:576
ds_write_b16_d16_hi v59, v51 offset:672
s_mov_b32 exec_hi, -1
ds_read_b128 v[16:19], v4 offset:0
ds_read_b128 v[20:23], v4 offset:16
ds_read_b128 v[24:27], v4 offset:32
ds_read_b128 v[28:31], v4 offset:48
ds_read_b128 v[32:35], v4 offset:64
ds_read_b128 v[36:39], v4 offset:80
s_waitcnt lgkmcnt(0)
s_load_dword s36, s[26:27], 0
v_perm_b32 v40, v16, v16, v8
v_perm_b32 v41, v16, v16, v9
v_perm_b32 v42, v16, v16, v10
v_perm_b32 v43, v16, v16, v11
v_perm_b32 v44, v16, v16, v12
v_perm_b32 v45, v16, v16, v13
v_perm_b32 v46, v16, v16, v14
v_perm_b32 v47, v16, v16, v15
s_waitcnt vmcnt(23)
v_mfma_f32_16x16x32_bf16 v[48:51], v[40:43], v[68:71], 0
v_perm_b32 v40, v17, v17, v8
v_perm_b32 v41, v17, v17, v9
v_perm_b32 v42, v17, v17, v10
v_perm_b32 v43, v17, v17, v11
s_waitcnt vmcnt(22)
v_mfma_f32_16x16x32_bf16 v[48:51], v[44:47], v[72:75], v[48:51]
v_perm_b32 v44, v17, v17, v12
v_perm_b32 v45, v17, v17, v13
v_perm_b32 v46, v17, v17, v14
v_perm_b32 v47, v17, v17, v15
s_waitcnt vmcnt(21)
v_mfma_f32_16x16x32_bf16 v[48:51], v[40:43], v[76:79], v[48:51]
v_perm_b32 v40, v18, v18, v8
v_perm_b32 v41, v18, v18, v9
v_perm_b32 v42, v18, v18, v10
v_perm_b32 v43, v18, v18, v11
s_waitcnt vmcnt(20)
v_mfma_f32_16x16x32_bf16 v[48:51], v[44:47], v[80:83], v[48:51]
v_perm_b32 v44, v18, v18, v12
v_perm_b32 v45, v18, v18, v13
v_perm_b32 v46, v18, v18, v14
v_perm_b32 v47, v18, v18, v15
s_waitcnt vmcnt(19)
v_mfma_f32_16x16x32_bf16 v[48:51], v[40:43], v[84:87], v[48:51]
v_perm_b32 v40, v19, v19, v8
v_perm_b32 v41, v19, v19, v9
v_perm_b32 v42, v19, v19, v10
v_perm_b32 v43, v19, v19, v11
s_waitcnt vmcnt(18)
v_mfma_f32_16x16x32_bf16 v[48:51], v[44:47], v[88:91], v[48:51]
v_perm_b32 v44, v19, v19, v12
v_perm_b32 v45, v19, v19, v13
v_perm_b32 v46, v19, v19, v14
v_perm_b32 v47, v19, v19, v15
s_waitcnt vmcnt(17)
v_mfma_f32_16x16x32_bf16 v[48:51], v[40:43], v[92:95], v[48:51]
buffer_load_dwordx4 v[164:167], v1, s[44:47], s64 offen nt
s_add_u32 s64, s64, s65
v_perm_b32 v40, v20, v20, v8
v_perm_b32 v41, v20, v20, v9
v_perm_b32 v42, v20, v20, v10
v_perm_b32 v43, v20, v20, v11
s_waitcnt vmcnt(17)
v_mfma_f32_16x16x32_bf16 v[48:51], v[44:47], v[96:99], v[48:51]
buffer_load_dwordx4 v[168:171], v1, s[44:47], s64 offen nt
s_add_u32 s64, s64, s65
v_perm_b32 v44, v20, v20, v12
v_perm_b32 v45, v20, v20, v13
v_perm_b32 v46, v20, v20, v14
v_perm_b32 v47, v20, v20, v15
s_waitcnt vmcnt(17)
v_mfma_f32_16x16x32_bf16 v[48:51], v[40:43], v[100:103], v[48:51]
buffer_load_dwordx4 v[172:175], v1, s[44:47], s64 offen nt
s_add_u32 s64, s64, s65
v_perm_b32 v40, v21, v21, v8
v_perm_b32 v41, v21, v21, v9
v_perm_b32 v42, v21, v21, v10
v_perm_b32 v43, v21, v21, v11
s_waitcnt vmcnt(17)
v_mfma_f32_16x16x32_bf16 v[48:51], v[44:47], v[104:107], v[48:51]
buffer_load_dwordx4 v[176:179], v1, s[44:47], s64 offen nt
s_add_u32 s64, s64, s65
v_perm_b32 v44, v21, v21, v12
v_perm_b32 v45, v21, v21, v13
v_perm_b32 v46, v21, v21, v14
v_perm_b32 v47, v21, v21, v15
s_mov_b32 s28, s26
s_mov_b32 s29, s27
s_mov_b32 s56, s16
s_mov_b32 s57, s17
s_mov_b32 s58, 7340032
s_mov_b32 s59, 0x20000
s_mov_b32 s60, s18
s_mov_b32 s61, s19
s_mov_b32 s62, 7340032
s_mov_b32 s63, 0x20000
s_cmp_gt_u32 s41, 3
s_cselect_b32 s79, 1, 0
s_sub_u32 s39, s39, s79
s_mov_b32 s74, s37
s_mov_b32 s77, 0
s_cmp_eq_u32 s41, 3
s_cbranch_scc0 L_g1
s_mov_b32 s77, 3
s_mov_b32 s79, 0xfaff65f0
s_cmp_eq_u32 s37, 1
s_cselect_b32 s79, 0xcbf87f31, s79
s_cmp_eq_u32 s37, 2
s_cselect_b32 s79, 0xdff9f4f2, s79
s_lshl_b32 s78, s42, 2
s_lshr_b32 s79, s79, s78
s_and_b32 s79, s79, 15
s_cmp_lt_u32 s79, 14
s_cbranch_scc0 L_g1
s_mov_b32 s77, 0
s_mov_b32 s74, 3
s_and_b32 s39, s79, 14
s_lshl_b32 s39, s39, 2
s_and_b32 s79, s79, 1
s_add_u32 s39, s39, s79
s_add_u32 s39, s39, 2
L_g1:
s_and_b32 s78, s39, 1
s_cselect_b32 s56, s18, s16
s_cselect_b32 s57, s19, s17
s_lshr_b32 s39, s39, 1
s_cmp_eq_u32 s77, 3
s_cselect_b32 s58, 0, s58
s_mov_b32 s75, 0
s_mul_i32 s76, s74, 344
s_lshl_b32 s79, s74, 8
s_and_b32 s67, s39, 3
s_cmp_eq_u32 s67, 1
s_cselect_b32 s75, 0x40000000, 0
s_cselect_b32 s76, s79, s76
s_lshl_b32 s79, s76, 1
v_lshlrev_b32 v5, 4, v0
v_add_u32 v5, s79, v5
buffer_load_dwordx4 v[60:63], v5, s[48:51], 0 offen
s_mul_i32 s66, s76, 7168
s_lshl_b32 s67, s39, 8
s_add_u32 s66, s66, s67
s_mov_b32 s67, 57344
v_mul_u32_u24 v5, 7168, v2
v_add_u32 v2, v5, v3
s_cmp_eq_u32 s37, 2
s_cselect_b32 s68, 0x40000000, 0
s_and_b32 s76, s68, s75
v_add_u32 v56, s68, v1
s_or_b32 s68, s68, s75
v_add_u32 v57, s68, v2
v_bfe_u32 v5, v0, 4, 1
v_lshl_add_u32 v3, v5, 7, v3
v_lshrrev_b32 v5, 5, v0
v_lshl_add_u32 v3, v5, 12, v3
s_lshl_b32 s68, s37, 14
s_lshl_b32 s69, s38, 8
s_add_u32 s68, s68, s69
s_add_u32 s68, s68, 81920
s_lshl_b32 s69, s39, 13
s_lshl_b32 s70, s78, 11
s_add_u32 s69, s69, s70
s_lshl_b32 s70, s74, 8
s_add_u32 s69, s69, s70
s_add_u32 s69, s69, 442368
s_lshl_b32 s73, s39, 10
s_lshl_b32 s70, s78, 4
s_add_u32 s73, s73, s70
s_lshl_b32 s70, s74, 2
s_add_u32 s73, s73, s70
s_add_u32 s73, s73, 704512
v_mov_b32 v58, 1
s_lshr_b32 s72, s38, 1
s_lshl_b32 s72, s72, 11
s_and_b32 s70, s38, 1
s_mul_i32 s70, s70, 3
s_add_u32 s70, s70, s37
s_lshl_b32 s70, s70, 2
s_add_u32 s72, s72, s70
s_add_u32 s72, s72, 16384
s_waitcnt vmcnt(18)
v_mfma_f32_16x16x32_bf16 v[48:51], v[40:43], v[108:111], v[48:51]
buffer_load_dwordx4 v[180:183], v1, s[44:47], s64 offen nt
s_add_u32 s64, s64, s65
v_perm_b32 v40, v22, v22, v8
v_perm_b32 v41, v22, v22, v9
v_perm_b32 v42, v22, v22, v10
v_perm_b32 v43, v22, v22, v11
s_waitcnt vmcnt(18)
v_mfma_f32_16x16x32_bf16 v[48:51], v[44:47], v[112:115], v[48:51]
buffer_load_dwordx4 v[184:187], v1, s[44:47], s64 offen nt
s_add_u32 s64, s64, s65
v_perm_b32 v44, v22, v22, v12
v_perm_b32 v45, v22, v22, v13
v_perm_b32 v46, v22, v22, v14
v_perm_b32 v47, v22, v22, v15
s_waitcnt vmcnt(18)
v_mfma_f32_16x16x32_bf16 v[48:51], v[40:43], v[116:119], v[48:51]
buffer_load_dwordx4 v[68:71], v1, s[44:47], s64 offen nt
s_add_u32 s64, s64, s65
v_perm_b32 v40, v23, v23, v8
v_perm_b32 v41, v23, v23, v9
v_perm_b32 v42, v23, v23, v10
v_perm_b32 v43, v23, v23, v11
s_waitcnt vmcnt(18)
v_mfma_f32_16x16x32_bf16 v[48:51], v[44:47], v[120:123], v[48:51]
buffer_load_dwordx4 v[72:75], v1, s[44:47], s64 offen nt
s_add_u32 s64, s64, s65
v_perm_b32 v44, v23, v23, v12
v_perm_b32 v45, v23, v23, v13
v_perm_b32 v46, v23, v23, v14
v_perm_b32 v47, v23, v23, v15
s_waitcnt vmcnt(18)
v_mfma_f32_16x16x32_bf16 v[48:51], v[40:43], v[124:127], v[48:51]
buffer_load_dwordx4 v[76:79], v1, s[44:47], s64 offen nt
s_add_u32 s64, s64, s65
v_perm_b32 v40, v24, v24, v8
v_perm_b32 v41, v24, v24, v9
v_perm_b32 v42, v24, v24, v10
v_perm_b32 v43, v24, v24, v11
s_waitcnt vmcnt(18)
v_mfma_f32_16x16x32_bf16 v[48:51], v[44:47], v[128:131], v[48:51]
buffer_load_dwordx4 v[80:83], v1, s[44:47], s64 offen nt
s_add_u32 s64, s64, s65
v_perm_b32 v44, v24, v24, v12
v_perm_b32 v45, v24, v24, v13
v_perm_b32 v46, v24, v24, v14
v_perm_b32 v47, v24, v24, v15
s_waitcnt vmcnt(18)
v_mfma_f32_16x16x32_bf16 v[48:51], v[40:43], v[132:135], v[48:51]
buffer_load_dwordx4 v[84:87], v1, s[44:47], s64 offen nt
s_add_u32 s64, s64, s65
v_perm_b32 v40, v25, v25, v8
v_perm_b32 v41, v25, v25, v9
v_perm_b32 v42, v25, v25, v10
v_perm_b32 v43, v25, v25, v11
s_waitcnt vmcnt(18)
v_mfma_f32_16x16x32_bf16 v[48:51], v[44:47], v[136:139], v[48:51]
buffer_load_dwordx4 v[88:91], v1, s[44:47], s64 offen nt
s_add_u32 s64, s64, s65
v_perm_b32 v44, v25, v25, v12
v_perm_b32 v45, v25, v25, v13
v_perm_b32 v46, v25, v25, v14
v_perm_b32 v47, v25, v25, v15
s_waitcnt vmcnt(18)
v_mfma_f32_16x16x32_bf16 v[48:51], v[40:43], v[140:143], v[48:51]
buffer_load_dwordx4 v[92:95], v1, s[44:47], s64 offen nt
s_add_u32 s64, s64, s65
v_perm_b32 v40, v26, v26, v8
v_perm_b32 v41, v26, v26, v9
v_perm_b32 v42, v26, v26, v10
v_perm_b32 v43, v26, v26, v11
s_waitcnt vmcnt(18)
v_mfma_f32_16x16x32_bf16 v[48:51], v[44:47], v[144:147], v[48:51]
buffer_load_dwordx4 v[96:99], v1, s[44:47], s64 offen nt
s_add_u32 s64, s64, s65
v_perm_b32 v44, v26, v26, v12
v_perm_b32 v45, v26, v26, v13
v_perm_b32 v46, v26, v26, v14
v_perm_b32 v47, v26, v26, v15
s_waitcnt vmcnt(18)
v_mfma_f32_16x16x32_bf16 v[48:51], v[40:43], v[148:151], v[48:51]
buffer_load_dwordx4 v[100:103], v1, s[44:47], s64 offen nt
s_add_u32 s64, s64, s65
v_perm_b32 v40, v27, v27, v8
v_perm_b32 v41, v27, v27, v9
v_perm_b32 v42, v27, v27, v10
v_perm_b32 v43, v27, v27, v11
s_waitcnt vmcnt(18)
v_mfma_f32_16x16x32_bf16 v[48:51], v[44:47], v[152:155], v[48:51]
buffer_load_dwordx4 v[104:107], v1, s[44:47], s64 offen nt
s_add_u32 s64, s64, s65
v_perm_b32 v44, v27, v27, v12
v_perm_b32 v45, v27, v27, v13
v_perm_b32 v46, v27, v27, v14
v_perm_b32 v47, v27, v27, v15
s_waitcnt vmcnt(18)
v_mfma_f32_16x16x32_bf16 v[48:51], v[40:43], v[156:159], v[48:51]
buffer_load_dwordx4 v[108:111], v1, s[44:47], s64 offen nt
s_add_u32 s64, s64, s65
v_perm_b32 v40, v28, v28, v8
v_perm_b32 v41, v28, v28, v9
v_perm_b32 v42, v28, v28, v10
v_perm_b32 v43, v28, v28, v11
s_waitcnt vmcnt(18)
v_mfma_f32_16x16x32_bf16 v[48:51], v[44:47], v[160:163], v[48:51]
buffer_load_dwordx4 v[112:115], v1, s[44:47], s64 offen nt
s_add_u32 s64, s64, s65
v_perm_b32 v44, v28, v28, v12
v_perm_b32 v45, v28, v28, v13
v_perm_b32 v46, v28, v28, v14
v_perm_b32 v47, v28, v28, v15
s_waitcnt vmcnt(18)
v_mfma_f32_16x16x32_bf16 v[48:51], v[40:43], v[164:167], v[48:51]
buffer_load_dwordx4 v[116:119], v56, s[44:47], s64 offen nt
v_perm_b32 v40, v29, v29, v8
v_perm_b32 v41, v29, v29, v9
v_perm_b32 v42, v29, v29, v10
v_perm_b32 v43, v29, v29, v11
s_waitcnt vmcnt(18)
v_mfma_f32_16x16x32_bf16 v[48:51], v[44:47], v[168:171], v[48:51]
buffer_load_dwordx4 v[120:123], v2, s[56:59], s66 offen offset:0 nt
v_perm_b32 v44, v29, v29, v12
v_perm_b32 v45, v29, v29, v13
v_perm_b32 v46, v29, v29, v14
v_perm_b32 v47, v29, v29, v15
s_waitcnt vmcnt(18)
v_mfma_f32_16x16x32_bf16 v[48:51], v[40:43], v[172:175], v[48:51]
buffer_load_dwordx4 v[124:127], v2, s[56:59], s66 offen offset:128 nt
s_add_u32 s66, s66, s67
v_perm_b32 v40, v30, v30, v8
v_perm_b32 v41, v30, v30, v9
v_perm_b32 v42, v30, v30, v10
v_perm_b32 v43, v30, v30, v11
s_waitcnt vmcnt(18)
v_mfma_f32_16x16x32_bf16 v[48:51], v[44:47], v[176:179], v[48:51]
buffer_load_dwordx4 v[128:131], v2, s[56:59], s66 offen offset:0 nt
v_perm_b32 v44, v30, v30, v12
v_perm_b32 v45, v30, v30, v13
v_perm_b32 v46, v30, v30, v14
v_perm_b32 v47, v30, v30, v15
s_waitcnt vmcnt(17)
v_mfma_f32_16x16x32_bf16 v[48:51], v[40:43], v[180:183], v[48:51]
buffer_load_dwordx4 v[132:135], v2, s[56:59], s66 offen offset:128 nt
s_add_u32 s66, s66, s67
v_perm_b32 v40, v31, v31, v8
v_perm_b32 v41, v31, v31, v9
v_perm_b32 v42, v31, v31, v10
v_perm_b32 v43, v31, v31, v11
s_waitcnt vmcnt(17)
v_mfma_f32_16x16x32_bf16 v[48:51], v[44:47], v[184:187], v[48:51]
buffer_load_dwordx4 v[136:139], v2, s[56:59], s66 offen offset:0 nt
v_perm_b32 v44, v31, v31, v12
v_perm_b32 v45, v31, v31, v13
v_perm_b32 v46, v31, v31, v14
v_perm_b32 v47, v31, v31, v15
s_waitcnt vmcnt(17)
v_mfma_f32_16x16x32_bf16 v[48:51], v[40:43], v[68:71], v[48:51]
buffer_load_dwordx4 v[140:143], v2, s[56:59], s66 offen offset:128 nt
s_add_u32 s66, s66, s67
v_perm_b32 v40, v32, v32, v8
v_perm_b32 v41, v32, v32, v9
v_perm_b32 v42, v32, v32, v10
v_perm_b32 v43, v32, v32, v11
s_waitcnt vmcnt(17)
v_mfma_f32_16x16x32_bf16 v[48:51], v[44:47], v[72:75], v[48:51]
buffer_load_dwordx4 v[144:147], v2, s[56:59], s66 offen offset:0 nt
v_perm_b32 v44, v32, v32, v12
v_perm_b32 v45, v32, v32, v13
v_perm_b32 v46, v32, v32, v14
v_perm_b32 v47, v32, v32, v15
s_waitcnt vmcnt(17)
v_mfma_f32_16x16x32_bf16 v[48:51], v[40:43], v[76:79], v[48:51]
buffer_load_dwordx4 v[148:151], v2, s[56:59], s66 offen offset:128 nt
s_add_u32 s66, s66, s67
v_perm_b32 v40, v33, v33, v8
v_perm_b32 v41, v33, v33, v9
v_perm_b32 v42, v33, v33, v10
v_perm_b32 v43, v33, v33, v11
s_waitcnt vmcnt(17)
v_mfma_f32_16x16x32_bf16 v[48:51], v[44:47], v[80:83], v[48:51]
buffer_load_dwordx4 v[152:155], v2, s[56:59], s66 offen offset:0 nt
v_perm_b32 v44, v33, v33, v12
v_perm_b32 v45, v33, v33, v13
v_perm_b32 v46, v33, v33, v14
v_perm_b32 v47, v33, v33, v15
s_waitcnt vmcnt(17)
v_mfma_f32_16x16x32_bf16 v[48:51], v[40:43], v[84:87], v[48:51]
buffer_load_dwordx4 v[156:159], v2, s[56:59], s66 offen offset:128 nt
s_add_u32 s66, s66, s67
v_perm_b32 v40, v34, v34, v8
v_perm_b32 v41, v34, v34, v9
v_perm_b32 v42, v34, v34, v10
v_perm_b32 v43, v34, v34, v11
s_waitcnt vmcnt(17)
v_mfma_f32_16x16x32_bf16 v[48:51], v[44:47], v[88:91], v[48:51]
buffer_load_dwordx4 v[160:163], v2, s[56:59], s66 offen offset:0 nt
v_perm_b32 v44, v34, v34, v12
v_perm_b32 v45, v34, v34, v13
v_perm_b32 v46, v34, v34, v14
v_perm_b32 v47, v34, v34, v15
s_waitcnt vmcnt(17)
v_mfma_f32_16x16x32_bf16 v[48:51], v[40:43], v[92:95], v[48:51]
buffer_load_dwordx4 v[164:167], v2, s[56:59], s66 offen offset:128 nt
s_add_u32 s66, s66, s67
v_perm_b32 v40, v35, v35, v8
v_perm_b32 v41, v35, v35, v9
v_perm_b32 v42, v35, v35, v10
v_perm_b32 v43, v35, v35, v11
s_waitcnt vmcnt(17)
v_mfma_f32_16x16x32_bf16 v[48:51], v[44:47], v[96:99], v[48:51]
buffer_load_dwordx4 v[168:171], v2, s[56:59], s66 offen offset:0 nt
v_perm_b32 v44, v35, v35, v12
v_perm_b32 v45, v35, v35, v13
v_perm_b32 v46, v35, v35, v14
v_perm_b32 v47, v35, v35, v15
s_waitcnt vmcnt(17)
v_mfma_f32_16x16x32_bf16 v[48:51], v[40:43], v[100:103], v[48:51]
buffer_load_dwordx4 v[172:175], v2, s[56:59], s66 offen offset:128 nt
s_add_u32 s66, s66, s67
v_perm_b32 v40, v36, v36, v8
v_perm_b32 v41, v36, v36, v9
v_perm_b32 v42, v36, v36, v10
v_perm_b32 v43, v36, v36, v11
s_waitcnt lgkmcnt(0)
s_add_u32 s32, s36, 1
s_add_u32 s33, s36, 38
s_add_u32 s34, s36, 75
s_add_u32 s35, s36, 112
s_and_b32 s32, s32, 0xff
s_and_b32 s33, s33, 0xff
s_and_b32 s34, s34, 0xff
s_and_b32 s35, s35, 0xff
s_mul_i32 s70, s36, 0x01010101
s_add_u32 s70, s70, 0x3c6ef301
s_mov_b32 s71, s70
v_mov_b32 v5, s36
ds_write_b32 v7, v5 offset:1028
v_mov_b32 v1, s70
v_lshlrev_b32 v56, 7, v0
s_waitcnt vmcnt(17)
v_mfma_f32_16x16x32_bf16 v[48:51], v[44:47], v[104:107], v[48:51]
buffer_load_dwordx4 v[176:179], v2, s[56:59], s66 offen offset:0 nt
v_perm_b32 v44, v36, v36, v12
v_perm_b32 v45, v36, v36, v13
v_perm_b32 v46, v36, v36, v14
v_perm_b32 v47, v36, v36, v15
s_waitcnt vmcnt(17)
v_mfma_f32_16x16x32_bf16 v[48:51], v[40:43], v[108:111], v[48:51]
buffer_load_dwordx4 v[180:183], v2, s[56:59], s66 offen offset:128 nt
s_add_u32 s66, s66, s67
v_perm_b32 v40, v37, v37, v8
v_perm_b32 v41, v37, v37, v9
v_perm_b32 v42, v37, v37, v10
v_perm_b32 v43, v37, v37, v11
s_waitcnt vmcnt(17)
v_mfma_f32_16x16x32_bf16 v[48:51], v[44:47], v[112:115], v[48:51]
buffer_load_dwordx4 v[184:187], v2, s[56:59], s66 offen offset:0 nt
s_waitcnt vmcnt(17)
v_mfma_f32_16x16x32_bf16 v[48:51], v[40:43], v[116:119], v[48:51]
buffer_load_dwordx4 v[68:71], v2, s[56:59], s66 offen offset:128 nt
s_add_u32 s66, s66, s67
s_nop 5
v_permlane32_swap_b32 v48, v52
v_permlane32_swap_b32 v49, v53
v_permlane32_swap_b32 v50, v54
v_permlane32_swap_b32 v51, v55
v_add_f32_dpp v48, v52, v48 row_ror:8 row_mask:0xf bank_mask:0xf
v_add_f32_dpp v49, v53, v49 row_ror:8 row_mask:0xf bank_mask:0xf
v_add_f32_dpp v50, v54, v50 row_ror:8 row_mask:0xf bank_mask:0xf
v_add_f32_dpp v51, v55, v51 row_ror:8 row_mask:0xf bank_mask:0xf
v_add_u32 v48, 0x80, v48
v_add_u32 v49, 0x80, v49
v_add_u32 v50, 0x80, v50
v_add_u32 v51, 0x80, v51
v_bfi_b32 v48, v6, s32, v48
v_bfi_b32 v49, v6, s33, v49
v_bfi_b32 v50, v6, s34, v50
v_bfi_b32 v51, v6, s35, v51
s_mov_b32 exec_lo, 0x00ff00ff
s_mov_b32 exec_hi, 0
buffer_store_dwordx4 v[48:51], v3, s[28:31], s68 offen sc1
s_mov_b64 exec, 15
buffer_store_dword v1, v56, s[28:31], s72 offen sc1
s_mov_b64 exec, -1
s_cmp_eq_u32 s77, 3
s_cbranch_scc0 L_S2
v_mov_b32 v58, 6
s_mov_b64 exec, 1
ds_add_u32 v7, v58 offset:1024
s_mov_b64 exec, -1
s_branch L_fin
L_S2:
s_cmp_eq_u32 s75, 0
s_cbranch_scc1 L_S2b
v_lshlrev_b32 v24, 16, v60
v_and_b32 v25, 0xffff0000, v60
v_lshlrev_b32 v26, 16, v61
v_and_b32 v27, 0xffff0000, v61
v_lshlrev_b32 v28, 16, v62
v_and_b32 v29, 0xffff0000, v62
v_lshlrev_b32 v30, 16, v63
v_and_b32 v31, 0xffff0000, v63
v_pk_add_f32 v[24:25], v[24:25], v[64:65] op_sel_hi:[1,0] neg_lo:[0,1] neg_hi:[0,1]
v_pk_add_f32 v[26:27], v[26:27], v[64:65] op_sel_hi:[1,0] neg_lo:[0,1] neg_hi:[0,1]
v_pk_add_f32 v[28:29], v[28:29], v[64:65] op_sel_hi:[1,0] neg_lo:[0,1] neg_hi:[0,1]
v_pk_add_f32 v[30:31], v[30:31], v[64:65] op_sel_hi:[1,0] neg_lo:[0,1] neg_hi:[0,1]
v_cvt_pk_bf16_f32 v60, v24, v25
v_cvt_pk_bf16_f32 v61, v26, v27
v_cvt_pk_bf16_f32 v62, v28, v29
v_cvt_pk_bf16_f32 v63, v30, v31
v_lshlrev_b32 v24, 16, v60
v_and_b32 v25, 0xffff0000, v60
v_lshlrev_b32 v26, 16, v61
v_and_b32 v27, 0xffff0000, v61
v_lshlrev_b32 v28, 16, v62
v_and_b32 v29, 0xffff0000, v62
v_lshlrev_b32 v30, 16, v63
v_and_b32 v31, 0xffff0000, v63
v_pk_mul_f32 v[24:25], v[24:25], v[66:67] op_sel_hi:[1,0]
v_pk_mul_f32 v[26:27], v[26:27], v[66:67] op_sel_hi:[1,0]
v_pk_mul_f32 v[28:29], v[28:29], v[66:67] op_sel_hi:[1,0]
v_pk_mul_f32 v[30:31], v[30:31], v[66:67] op_sel_hi:[1,0]
v_cvt_pk_bf16_f32 v60, v24, v25
v_cvt_pk_bf16_f32 v61, v26, v27
v_cvt_pk_bf16_f32 v62, v28, v29
v_cvt_pk_bf16_f32 v63, v30, v31
s_mov_b32 exec_hi, 0xffff
ds_write_b16 v59, v60 offset:0
ds_write_b16_d16_hi v59, v60 offset:96
ds_write_b16 v59, v61 offset:192
ds_write_b16_d16_hi v59, v61 offset:288
ds_write_b16 v59, v62 offset:384
ds_write_b16_d16_hi v59, v62 offset:480
ds_write_b16 v59, v63 offset:576
ds_write_b16_d16_hi v59, v63 offset:672
s_mov_b32 exec_hi, -1
ds_read_b128 v[16:19], v4 offset:0
ds_read_b128 v[20:23], v4 offset:16
ds_read_b128 v[24:27], v4 offset:32
ds_read_b128 v[28:31], v4 offset:48
ds_read_b128 v[32:35], v4 offset:64
ds_read_b128 v[36:39], v4 offset:80
s_waitcnt lgkmcnt(0)
L_S2b:
v_perm_b32 v40, v16, v16, v8
v_perm_b32 v41, v16, v16, v9
v_perm_b32 v42, v16, v16, v10
v_perm_b32 v43, v16, v16, v11
v_perm_b32 v44, v16, v16, v12
v_perm_b32 v45, v16, v16, v13
v_perm_b32 v46, v16, v16, v14
v_perm_b32 v47, v16, v16, v15
s_waitcnt vmcnt(19)
v_mfma_f32_16x16x32_bf16 v[48:51], v[40:43], v[120:123], 0
buffer_load_dwordx4 v[72:75], v2, s[56:59], s66 offen offset:0 nt
buffer_load_dwordx4 v[76:79], v2, s[56:59], s66 offen offset:128 nt
s_add_u32 s66, s66, s67
s_waitcnt vmcnt(20)
v_mfma_f32_16x16x32_bf16 v[52:55], v[40:43], v[124:127], 0
buffer_load_dwordx4 v[80:83], v2, s[56:59], s66 offen offset:0 nt
buffer_load_dwordx4 v[84:87], v2, s[56:59], s66 offen offset:128 nt
s_add_u32 s66, s66, s67
v_perm_b32 v40, v17, v17, v8
v_perm_b32 v41, v17, v17, v9
v_perm_b32 v42, v17, v17, v10
v_perm_b32 v43, v17, v17, v11
s_waitcnt vmcnt(21)
v_mfma_f32_16x16x32_bf16 v[48:51], v[44:47], v[128:131], v[48:51]
buffer_load_dwordx4 v[88:91], v2, s[56:59], s66 offen offset:0 nt
buffer_load_dwordx4 v[92:95], v2, s[56:59], s66 offen offset:128 nt
s_add_u32 s66, s66, s67
s_waitcnt vmcnt(22)
v_mfma_f32_16x16x32_bf16 v[52:55], v[44:47], v[132:135], v[52:55]
buffer_load_dwordx4 v[96:99], v2, s[56:59], s66 offen offset:0 nt
buffer_load_dwordx4 v[100:103], v2, s[56:59], s66 offen offset:128 nt
s_add_u32 s66, s66, s67
v_perm_b32 v44, v17, v17, v12
v_perm_b32 v45, v17, v17, v13
v_perm_b32 v46, v17, v17, v14
v_perm_b32 v47, v17, v17, v15
s_waitcnt vmcnt(23)
v_mfma_f32_16x16x32_bf16 v[48:51], v[40:43], v[136:139], v[48:51]
buffer_load_dwordx4 v[104:107], v2, s[56:59], s66 offen offset:0 nt
buffer_load_dwordx4 v[108:111], v2, s[56:59], s66 offen offset:128 nt
s_add_u32 s66, s66, s67
s_waitcnt vmcnt(24)
v_mfma_f32_16x16x32_bf16 v[52:55], v[40:43], v[140:143], v[52:55]
buffer_load_dwordx4 v[112:115], v2, s[56:59], s66 offen offset:0 nt
buffer_load_dwordx4 v[116:119], v2, s[56:59], s66 offen offset:128 nt
s_add_u32 s66, s66, s67
v_perm_b32 v40, v18, v18, v8
v_perm_b32 v41, v18, v18, v9
v_perm_b32 v42, v18, v18, v10
v_perm_b32 v43, v18, v18, v11
s_waitcnt vmcnt(25)
v_mfma_f32_16x16x32_bf16 v[48:51], v[44:47], v[144:147], v[48:51]
buffer_load_dwordx4 v[120:123], v2, s[56:59], s66 offen offset:0 nt
buffer_load_dwordx4 v[124:127], v2, s[56:59], s66 offen offset:128 nt
s_add_u32 s66, s66, s67
s_waitcnt vmcnt(26)
v_mfma_f32_16x16x32_bf16 v[52:55], v[44:47], v[148:151], v[52:55]
buffer_load_dwordx4 v[128:131], v2, s[56:59], s66 offen offset:0 nt
buffer_load_dwordx4 v[132:135], v2, s[56:59], s66 offen offset:128 nt
s_add_u32 s66, s66, s67
v_perm_b32 v44, v18, v18, v12
v_perm_b32 v45, v18, v18, v13
v_perm_b32 v46, v18, v18, v14
v_perm_b32 v47, v18, v18, v15
s_waitcnt vmcnt(27)
v_mfma_f32_16x16x32_bf16 v[48:51], v[40:43], v[152:155], v[48:51]
buffer_load_dwordx4 v[136:139], v2, s[56:59], s66 offen offset:0 nt
buffer_load_dwordx4 v[140:143], v2, s[56:59], s66 offen offset:128 nt
s_add_u32 s66, s66, s67
s_waitcnt vmcnt(28)
v_mfma_f32_16x16x32_bf16 v[52:55], v[40:43], v[156:159], v[52:55]
buffer_load_dwordx4 v[144:147], v2, s[56:59], s66 offen offset:0 nt
buffer_load_dwordx4 v[148:151], v2, s[56:59], s66 offen offset:128 nt
s_add_u32 s66, s66, s67
v_perm_b32 v40, v19, v19, v8
v_perm_b32 v41, v19, v19, v9
v_perm_b32 v42, v19, v19, v10
v_perm_b32 v43, v19, v19, v11
s_waitcnt vmcnt(29)
v_mfma_f32_16x16x32_bf16 v[48:51], v[44:47], v[160:163], v[48:51]
buffer_load_dwordx4 v[152:155], v2, s[56:59], s66 offen offset:0 nt
buffer_load_dwordx4 v[156:159], v2, s[56:59], s66 offen offset:128 nt
s_add_u32 s66, s66, s67
s_waitcnt vmcnt(30)
v_mfma_f32_16x16x32_bf16 v[52:55], v[44:47], v[164:167], v[52:55]
buffer_load_dwordx4 v[160:163], v2, s[56:59], s66 offen offset:0 nt
buffer_load_dwordx4 v[164:167], v2, s[56:59], s66 offen offset:128 nt
s_add_u32 s66, s66, s67
s_cmp_eq_u32 s75, 0
s_cbranch_scc1 T_1
s_mov_b64 exec, 1
ds_add_u32 v7, v58 offset:1024
s_mov_b64 exec, -1
T_1:
v_perm_b32 v44, v19, v19, v12
v_perm_b32 v45, v19, v19, v13
v_perm_b32 v46, v19, v19, v14
v_perm_b32 v47, v19, v19, v15
s_waitcnt vmcnt(31)
v_mfma_f32_16x16x32_bf16 v[48:51], v[40:43], v[168:171], v[48:51]
buffer_load_dwordx4 v[168:171], v2, s[56:59], s66 offen offset:0 nt
s_waitcnt vmcnt(31)
v_mfma_f32_16x16x32_bf16 v[52:55], v[40:43], v[172:175], v[52:55]
buffer_load_dwordx4 v[172:175], v2, s[56:59], s66 offen offset:128 nt
s_add_u32 s66, s66, s67
v_perm_b32 v40, v20, v20, v8
v_perm_b32 v41, v20, v20, v9
v_perm_b32 v42, v20, v20, v10
v_perm_b32 v43, v20, v20, v11
s_waitcnt vmcnt(31)
v_mfma_f32_16x16x32_bf16 v[48:51], v[44:47], v[176:179], v[48:51]
buffer_load_dwordx4 v[176:179], v2, s[56:59], s66 offen offset:0 nt
s_waitcnt vmcnt(31)
v_mfma_f32_16x16x32_bf16 v[52:55], v[44:47], v[180:183], v[52:55]
buffer_load_dwordx4 v[180:183], v2, s[56:59], s66 offen offset:128 nt
s_add_u32 s66, s66, s67
v_perm_b32 v44, v20, v20, v12
v_perm_b32 v45, v20, v20, v13
v_perm_b32 v46, v20, v20, v14
v_perm_b32 v47, v20, v20, v15
s_waitcnt vmcnt(31)
v_mfma_f32_16x16x32_bf16 v[48:51], v[40:43], v[184:187], v[48:51]
buffer_load_dwordx4 v[184:187], v2, s[56:59], s66 offen offset:0 nt
s_waitcnt vmcnt(31)
v_mfma_f32_16x16x32_bf16 v[52:55], v[40:43], v[68:71], v[52:55]
buffer_load_dwordx4 v[68:71], v2, s[56:59], s66 offen offset:128 nt
s_add_u32 s66, s66, s67
v_perm_b32 v40, v21, v21, v8
v_perm_b32 v41, v21, v21, v9
v_perm_b32 v42, v21, v21, v10
v_perm_b32 v43, v21, v21, v11
s_waitcnt vmcnt(29)
v_mfma_f32_16x16x32_bf16 v[48:51], v[44:47], v[72:75], v[48:51]
buffer_load_dwordx4 v[72:75], v2, s[56:59], s66 offen offset:0 nt
s_waitcnt vmcnt(29)
v_mfma_f32_16x16x32_bf16 v[52:55], v[44:47], v[76:79], v[52:55]
buffer_load_dwordx4 v[76:79], v2, s[56:59], s66 offen offset:128 nt
s_add_u32 s66, s66, s67
s_cmp_eq_u32 s75, 0
s_cbranch_scc1 T_2
s_mov_b64 exec, 1
ds_add_u32 v7, v58 offset:1024
s_mov_b64 exec, -1
T_2:
v_perm_b32 v44, v21, v21, v12
v_perm_b32 v45, v21, v21, v13
v_perm_b32 v46, v21, v21, v14
v_perm_b32 v47, v21, v21, v15
s_waitcnt vmcnt(29)
v_mfma_f32_16x16x32_bf16 v[48:51], v[40:43], v[80:83], v[48:51]
buffer_load_dwordx4 v[80:83], v2, s[56:59], s66 offen offset:0 nt
s_waitcnt vmcnt(29)
v_mfma_f32_16x16x32_bf16 v[52:55], v[40:43], v[84:87], v[52:55]
buffer_load_dwordx4 v[84:87], v2, s[56:59], s66 offen offset:128 nt
s_add_u32 s66, s66, s67
v_perm_b32 v40, v22, v22, v8
v_perm_b32 v41, v22, v22, v9
v_perm_b32 v42, v22, v22, v10
v_perm_b32 v43, v22, v22, v11
s_waitcnt vmcnt(29)
v_mfma_f32_16x16x32_bf16 v[48:51], v[44:47], v[88:91], v[48:51]
buffer_load_dwordx4 v[88:91], v2, s[56:59], s66 offen offset:0 nt
s_waitcnt vmcnt(29)
v_mfma_f32_16x16x32_bf16 v[52:55], v[44:47], v[92:95], v[52:55]
buffer_load_dwordx4 v[92:95], v2, s[56:59], s66 offen offset:128 nt
s_add_u32 s66, s66, s67
v_perm_b32 v44, v22, v22, v12
v_perm_b32 v45, v22, v22, v13
v_perm_b32 v46, v22, v22, v14
v_perm_b32 v47, v22, v22, v15
s_waitcnt vmcnt(29)
v_mfma_f32_16x16x32_bf16 v[48:51], v[40:43], v[96:99], v[48:51]
buffer_load_dwordx4 v[96:99], v2, s[56:59], s66 offen offset:0 nt
s_waitcnt vmcnt(29)
v_mfma_f32_16x16x32_bf16 v[52:55], v[40:43], v[100:103], v[52:55]
buffer_load_dwordx4 v[100:103], v2, s[56:59], s66 offen offset:128 nt
s_add_u32 s66, s66, s67
v_perm_b32 v40, v23, v23, v8
v_perm_b32 v41, v23, v23, v9
v_perm_b32 v42, v23, v23, v10
v_perm_b32 v43, v23, v23, v11
s_waitcnt vmcnt(29)
v_mfma_f32_16x16x32_bf16 v[48:51], v[44:47], v[104:107], v[48:51]
buffer_load_dwordx4 v[104:107], v2, s[56:59], s66 offen offset:0 nt
s_waitcnt vmcnt(29)
v_mfma_f32_16x16x32_bf16 v[52:55], v[44:47], v[108:111], v[52:55]
buffer_load_dwordx4 v[108:111], v2, s[56:59], s66 offen offset:128 nt
s_add_u32 s66, s66, s67
s_cmp_eq_u32 s75, 0
s_cbranch_scc1 T_3
s_mov_b64 exec, 1
ds_add_u32 v7, v58 offset:1024
s_mov_b64 exec, -1
T_3:
v_perm_b32 v44, v23, v23, v12
v_perm_b32 v45, v23, v23, v13
v_perm_b32 v46, v23, v23, v14
v_perm_b32 v47, v23, v23, v15
s_waitcnt vmcnt(29)
v_mfma_f32_16x16x32_bf16 v[48:51], v[40:43], v[112:115], v[48:51]
buffer_load_dwordx4 v[112:115], v2, s[56:59], s66 offen offset:0 nt
s_waitcnt vmcnt(29)
v_mfma_f32_16x16x32_bf16 v[52:55], v[40:43], v[116:119], v[52:55]
buffer_load_dwordx4 v[116:119], v2, s[56:59], s66 offen offset:128 nt
s_add_u32 s66, s66, s67
v_perm_b32 v40, v24, v24, v8
v_perm_b32 v41, v24, v24, v9
v_perm_b32 v42, v24, v24, v10
v_perm_b32 v43, v24, v24, v11
s_waitcnt vmcnt(29)
v_mfma_f32_16x16x32_bf16 v[48:51], v[44:47], v[120:123], v[48:51]
buffer_load_dwordx4 v[120:123], v2, s[56:59], s66 offen offset:0 nt
s_waitcnt vmcnt(29)
v_mfma_f32_16x16x32_bf16 v[52:55], v[44:47], v[124:127], v[52:55]
buffer_load_dwordx4 v[124:127], v2, s[56:59], s66 offen offset:128 nt
s_add_u32 s66, s66, s67
v_perm_b32 v44, v24, v24, v12
v_perm_b32 v45, v24, v24, v13
v_perm_b32 v46, v24, v24, v14
v_perm_b32 v47, v24, v24, v15
s_waitcnt vmcnt(29)
v_mfma_f32_16x16x32_bf16 v[48:51], v[40:43], v[128:131], v[48:51]
buffer_load_dwordx4 v[128:131], v2, s[56:59], s66 offen offset:0 nt
s_waitcnt vmcnt(29)
v_mfma_f32_16x16x32_bf16 v[52:55], v[40:43], v[132:135], v[52:55]
buffer_load_dwordx4 v[132:135], v2, s[56:59], s66 offen offset:128 nt
s_add_u32 s66, s66, s67
v_perm_b32 v40, v25, v25, v8
v_perm_b32 v41, v25, v25, v9
v_perm_b32 v42, v25, v25, v10
v_perm_b32 v43, v25, v25, v11
s_waitcnt vmcnt(29)
v_mfma_f32_16x16x32_bf16 v[48:51], v[44:47], v[136:139], v[48:51]
v_add_u32 v2, s75, v2
buffer_load_dwordx4 v[136:139], v2, s[56:59], s66 offen offset:0 nt
s_waitcnt vmcnt(29)
v_mfma_f32_16x16x32_bf16 v[52:55], v[44:47], v[140:143], v[52:55]
buffer_load_dwordx4 v[140:143], v2, s[56:59], s66 offen offset:128 nt
s_add_u32 s66, s66, s67
s_mov_b64 exec, 1
ds_add_u32 v7, v58 offset:1024
s_mov_b64 exec, -1
v_perm_b32 v44, v25, v25, v12
v_perm_b32 v45, v25, v25, v13
v_perm_b32 v46, v25, v25, v14
v_perm_b32 v47, v25, v25, v15
s_waitcnt vmcnt(29)
v_mfma_f32_16x16x32_bf16 v[48:51], v[40:43], v[144:147], v[48:51]
buffer_load_dwordx4 v[144:147], v2, s[56:59], s66 offen offset:0 nt
s_waitcnt vmcnt(29)
v_mfma_f32_16x16x32_bf16 v[52:55], v[40:43], v[148:151], v[52:55]
buffer_load_dwordx4 v[148:151], v2, s[56:59], s66 offen offset:128 nt
s_add_u32 s66, s66, s67
v_perm_b32 v40, v26, v26, v8
v_perm_b32 v41, v26, v26, v9
v_perm_b32 v42, v26, v26, v10
v_perm_b32 v43, v26, v26, v11
s_waitcnt vmcnt(29)
v_mfma_f32_16x16x32_bf16 v[48:51], v[44:47], v[152:155], v[48:51]
buffer_load_dwordx4 v[152:155], v2, s[56:59], s66 offen offset:0 nt
s_waitcnt vmcnt(29)
v_mfma_f32_16x16x32_bf16 v[52:55], v[44:47], v[156:159], v[52:55]
buffer_load_dwordx4 v[156:159], v2, s[56:59], s66 offen offset:128 nt
s_add_u32 s66, s66, s67
v_perm_b32 v44, v26, v26, v12
v_perm_b32 v45, v26, v26, v13
v_perm_b32 v46, v26, v26, v14
v_perm_b32 v47, v26, v26, v15
s_waitcnt vmcnt(29)
v_mfma_f32_16x16x32_bf16 v[48:51], v[40:43], v[160:163], v[48:51]
buffer_load_dwordx4 v[160:163], v2, s[56:59], s66 offen offset:0 nt
s_waitcnt vmcnt(29)
v_mfma_f32_16x16x32_bf16 v[52:55], v[40:43], v[164:167], v[52:55]
buffer_load_dwordx4 v[164:167], v2, s[56:59], s66 offen offset:128 nt
s_add_u32 s66, s66, s67
v_perm_b32 v40, v27, v27, v8
v_perm_b32 v41, v27, v27, v9
v_perm_b32 v42, v27, v27, v10
v_perm_b32 v43, v27, v27, v11
s_waitcnt vmcnt(29)
v_mfma_f32_16x16x32_bf16 v[48:51], v[44:47], v[168:171], v[48:51]
buffer_load_dwordx4 v[168:171], v2, s[56:59], s66 offen offset:0 nt
s_waitcnt vmcnt(29)
v_mfma_f32_16x16x32_bf16 v[52:55], v[44:47], v[172:175], v[52:55]
buffer_load_dwordx4 v[172:175], v2, s[56:59], s66 offen offset:128 nt
s_add_u32 s66, s66, s67
s_mov_b64 exec, 1
ds_add_u32 v7, v58 offset:1024
s_mov_b64 exec, -1
v_perm_b32 v44, v27, v27, v12
v_perm_b32 v45, v27, v27, v13
v_perm_b32 v46, v27, v27, v14
v_perm_b32 v47, v27, v27, v15
s_waitcnt vmcnt(29)
v_mfma_f32_16x16x32_bf16 v[48:51], v[40:43], v[176:179], v[48:51]
buffer_load_dwordx4 v[176:179], v2, s[56:59], s66 offen offset:0 nt
s_waitcnt vmcnt(29)
v_mfma_f32_16x16x32_bf16 v[52:55], v[40:43], v[180:183], v[52:55]
buffer_load_dwordx4 v[180:183], v2, s[56:59], s66 offen offset:128 nt
s_add_u32 s66, s66, s67
v_perm_b32 v40, v28, v28, v8
v_perm_b32 v41, v28, v28, v9
v_perm_b32 v42, v28, v28, v10
v_perm_b32 v43, v28, v28, v11
s_waitcnt vmcnt(29)
v_mfma_f32_16x16x32_bf16 v[48:51], v[44:47], v[184:187], v[48:51]
buffer_load_dwordx4 v[184:187], v2, s[56:59], s66 offen offset:0 nt
s_waitcnt vmcnt(29)
v_mfma_f32_16x16x32_bf16 v[52:55], v[44:47], v[68:71], v[52:55]
buffer_load_dwordx4 v[68:71], v2, s[56:59], s66 offen offset:128 nt
s_add_u32 s66, s66, s67
v_perm_b32 v44, v28, v28, v12
v_perm_b32 v45, v28, v28, v13
v_perm_b32 v46, v28, v28, v14
v_perm_b32 v47, v28, v28, v15
s_waitcnt vmcnt(29)
v_mfma_f32_16x16x32_bf16 v[48:51], v[40:43], v[72:75], v[48:51]
buffer_load_dwordx4 v[72:75], v2, s[56:59], s66 offen offset:0 nt
s_waitcnt vmcnt(29)
v_mfma_f32_16x16x32_bf16 v[52:55], v[40:43], v[76:79], v[52:55]
buffer_load_dwordx4 v[76:79], v2, s[56:59], s66 offen offset:128 nt
s_add_u32 s66, s66, s67
v_perm_b32 v40, v29, v29, v8
v_perm_b32 v41, v29, v29, v9
v_perm_b32 v42, v29, v29, v10
v_perm_b32 v43, v29, v29, v11
s_waitcnt vmcnt(29)
v_mfma_f32_16x16x32_bf16 v[48:51], v[44:47], v[80:83], v[48:51]
buffer_load_dwordx4 v[80:83], v2, s[56:59], s66 offen offset:0 nt
s_waitcnt vmcnt(29)
v_mfma_f32_16x16x32_bf16 v[52:55], v[44:47], v[84:87], v[52:55]
buffer_load_dwordx4 v[84:87], v2, s[56:59], s66 offen offset:128 nt
s_add_u32 s66, s66, s67
s_mov_b64 exec, 1
ds_add_u32 v7, v58 offset:1024
s_mov_b64 exec, -1
v_perm_b32 v44, v29, v29, v12
v_perm_b32 v45, v29, v29, v13
v_perm_b32 v46, v29, v29, v14
v_perm_b32 v47, v29, v29, v15
s_waitcnt vmcnt(29)
v_mfma_f32_16x16x32_bf16 v[48:51], v[40:43], v[88:91], v[48:51]
buffer_load_dwordx4 v[88:91], v2, s[56:59], s66 offen offset:0 nt
s_waitcnt vmcnt(29)
v_mfma_f32_16x16x32_bf16 v[52:55], v[40:43], v[92:95], v[52:55]
buffer_load_dwordx4 v[92:95], v2, s[56:59], s66 offen offset:128 nt
s_add_u32 s66, s66, s67
v_perm_b32 v40, v30, v30, v8
v_perm_b32 v41, v30, v30, v9
v_perm_b32 v42, v30, v30, v10
v_perm_b32 v43, v30, v30, v11
s_waitcnt vmcnt(29)
v_mfma_f32_16x16x32_bf16 v[48:51], v[44:47], v[96:99], v[48:51]
buffer_load_dwordx4 v[96:99], v57, s[56:59], s66 offen offset:0 nt
s_waitcnt vmcnt(29)
v_mfma_f32_16x16x32_bf16 v[52:55], v[44:47], v[100:103], v[52:55]
buffer_load_dwordx4 v[100:103], v57, s[56:59], s66 offen offset:128 nt
v_perm_b32 v44, v30, v30, v12
v_perm_b32 v45, v30, v30, v13
v_perm_b32 v46, v30, v30, v14
v_perm_b32 v47, v30, v30, v15
s_waitcnt vmcnt(29)
v_mfma_f32_16x16x32_bf16 v[48:51], v[40:43], v[104:107], v[48:51]
s_waitcnt vmcnt(28)
v_mfma_f32_16x16x32_bf16 v[52:55], v[40:43], v[108:111], v[52:55]
v_perm_b32 v40, v31, v31, v8
v_perm_b32 v41, v31, v31, v9
v_perm_b32 v42, v31, v31, v10
v_perm_b32 v43, v31, v31, v11
s_waitcnt vmcnt(27)
v_mfma_f32_16x16x32_bf16 v[48:51], v[44:47], v[112:115], v[48:51]
s_waitcnt vmcnt(26)
v_mfma_f32_16x16x32_bf16 v[52:55], v[44:47], v[116:119], v[52:55]
s_mov_b64 exec, 1
ds_add_u32 v7, v58 offset:1024
s_mov_b64 exec, -1
v_perm_b32 v44, v31, v31, v12
v_perm_b32 v45, v31, v31, v13
v_perm_b32 v46, v31, v31, v14
v_perm_b32 v47, v31, v31, v15
s_waitcnt vmcnt(25)
v_mfma_f32_16x16x32_bf16 v[48:51], v[40:43], v[120:123], v[48:51]
s_waitcnt vmcnt(24)
v_mfma_f32_16x16x32_bf16 v[52:55], v[40:43], v[124:127], v[52:55]
v_perm_b32 v40, v32, v32, v8
v_perm_b32 v41, v32, v32, v9
v_perm_b32 v42, v32, v32, v10
v_perm_b32 v43, v32, v32, v11
s_waitcnt vmcnt(23)
v_mfma_f32_16x16x32_bf16 v[48:51], v[44:47], v[128:131], v[48:51]
s_waitcnt vmcnt(22)
v_mfma_f32_16x16x32_bf16 v[52:55], v[44:47], v[132:135], v[52:55]
s_cmp_lg_u32 s75, 0
s_cbranch_scc1 L_S3
v_perm_b32 v44, v32, v32, v12
v_perm_b32 v45, v32, v32, v13
v_perm_b32 v46, v32, v32, v14
v_perm_b32 v47, v32, v32, v15
s_waitcnt vmcnt(21)
v_mfma_f32_16x16x32_bf16 v[48:51], v[40:43], v[136:139], v[48:51]
s_waitcnt vmcnt(20)
v_mfma_f32_16x16x32_bf16 v[52:55], v[40:43], v[140:143], v[52:55]
v_perm_b32 v40, v33, v33, v8
v_perm_b32 v41, v33, v33, v9
v_perm_b32 v42, v33, v33, v10
v_perm_b32 v43, v33, v33, v11
s_waitcnt vmcnt(19)
v_mfma_f32_16x16x32_bf16 v[48:51], v[44:47], v[144:147], v[48:51]
s_waitcnt vmcnt(18)
v_mfma_f32_16x16x32_bf16 v[52:55], v[44:47], v[148:151], v[52:55]
s_mov_b64 exec, 1
ds_add_u32 v7, v58 offset:1024
s_mov_b64 exec, -1
v_perm_b32 v44, v33, v33, v12
v_perm_b32 v45, v33, v33, v13
v_perm_b32 v46, v33, v33, v14
v_perm_b32 v47, v33, v33, v15
s_waitcnt vmcnt(17)
v_mfma_f32_16x16x32_bf16 v[48:51], v[40:43], v[152:155], v[48:51]
s_waitcnt vmcnt(16)
v_mfma_f32_16x16x32_bf16 v[52:55], v[40:43], v[156:159], v[52:55]
v_perm_b32 v40, v34, v34, v8
v_perm_b32 v41, v34, v34, v9
v_perm_b32 v42, v34, v34, v10
v_perm_b32 v43, v34, v34, v11
s_waitcnt vmcnt(15)
v_mfma_f32_16x16x32_bf16 v[48:51], v[44:47], v[160:163], v[48:51]
s_waitcnt vmcnt(14)
v_mfma_f32_16x16x32_bf16 v[52:55], v[44:47], v[164:167], v[52:55]
v_perm_b32 v44, v34, v34, v12
v_perm_b32 v45, v34, v34, v13
v_perm_b32 v46, v34, v34, v14
v_perm_b32 v47, v34, v34, v15
s_waitcnt vmcnt(13)
v_mfma_f32_16x16x32_bf16 v[48:51], v[40:43], v[168:171], v[48:51]
s_waitcnt vmcnt(12)
v_mfma_f32_16x16x32_bf16 v[52:55], v[40:43], v[172:175], v[52:55]
v_perm_b32 v40, v35, v35, v8
v_perm_b32 v41, v35, v35, v9
v_perm_b32 v42, v35, v35, v10
v_perm_b32 v43, v35, v35, v11
s_waitcnt vmcnt(11)
v_mfma_f32_16x16x32_bf16 v[48:51], v[44:47], v[176:179], v[48:51]
s_waitcnt vmcnt(10)
v_mfma_f32_16x16x32_bf16 v[52:55], v[44:47], v[180:183], v[52:55]
s_mov_b64 exec, 1
ds_add_u32 v7, v58 offset:1024
s_mov_b64 exec, -1
v_perm_b32 v44, v35, v35, v12
v_perm_b32 v45, v35, v35, v13
v_perm_b32 v46, v35, v35, v14
v_perm_b32 v47, v35, v35, v15
s_waitcnt vmcnt(9)
v_mfma_f32_16x16x32_bf16 v[48:51], v[40:43], v[184:187], v[48:51]
s_waitcnt vmcnt(8)
v_mfma_f32_16x16x32_bf16 v[52:55], v[40:43], v[68:71], v[52:55]
v_perm_b32 v40, v36, v36, v8
v_perm_b32 v41, v36, v36, v9
v_perm_b32 v42, v36, v36, v10
v_perm_b32 v43, v36, v36, v11
s_waitcnt vmcnt(7)
v_mfma_f32_16x16x32_bf16 v[48:51], v[44:47], v[72:75], v[48:51]
s_waitcnt vmcnt(6)
v_mfma_f32_16x16x32_bf16 v[52:55], v[44:47], v[76:79], v[52:55]
v_perm_b32 v44, v36, v36, v12
v_perm_b32 v45, v36, v36, v13
v_perm_b32 v46, v36, v36, v14
v_perm_b32 v47, v36, v36, v15
s_waitcnt vmcnt(5)
v_mfma_f32_16x16x32_bf16 v[48:51], v[40:43], v[80:83], v[48:51]
s_waitcnt vmcnt(4)
v_mfma_f32_16x16x32_bf16 v[52:55], v[40:43], v[84:87], v[52:55]
v_perm_b32 v40, v37, v37, v8
v_perm_b32 v41, v37, v37, v9
v_perm_b32 v42, v37, v37, v10
v_perm_b32 v43, v37, v37, v11
s_waitcnt vmcnt(3)
v_mfma_f32_16x16x32_bf16 v[48:51], v[44:47], v[88:91], v[48:51]
s_waitcnt vmcnt(2)
v_mfma_f32_16x16x32_bf16 v[52:55], v[44:47], v[92:95], v[52:55]
s_mov_b64 exec, 1
ds_add_u32 v7, v58 offset:1024
s_mov_b64 exec, -1
s_waitcnt vmcnt(1)
v_mfma_f32_16x16x32_bf16 v[48:51], v[40:43], v[96:99], v[48:51]
s_waitcnt vmcnt(0)
v_mfma_f32_16x16x32_bf16 v[52:55], v[40:43], v[100:103], v[52:55]
L_S3:
s_nop 7
v_permlane32_swap_b32 v48, v52
v_permlane32_swap_b32 v49, v53
v_permlane32_swap_b32 v50, v54
v_permlane32_swap_b32 v51, v55
v_add_f32_dpp v48, v52, v48 row_ror:8 row_mask:0xf bank_mask:0xf
v_add_f32_dpp v49, v53, v49 row_ror:8 row_mask:0xf bank_mask:0xf
v_add_f32_dpp v50, v54, v50 row_ror:8 row_mask:0xf bank_mask:0xf
v_add_f32_dpp v51, v55, v51 row_ror:8 row_mask:0xf bank_mask:0xf
v_add_u32 v48, 0x80, v48
v_add_u32 v49, 0x80, v49
v_add_u32 v50, 0x80, v50
v_add_u32 v51, 0x80, v51
v_bfi_b32 v48, v6, s32, v48
v_bfi_b32 v49, v6, s33, v49
v_bfi_b32 v50, v6, s34, v50
v_bfi_b32 v51, v6, s35, v51
s_mov_b32 exec_lo, 0x00ff00ff
s_mov_b32 exec_hi, 0x00ff00ff
buffer_store_dwordx4 v[48:51], v3, s[28:31], s69 offen sc1
s_mov_b64 exec, 0xff
buffer_store_dword v1, v56, s[28:31], s73 offen sc1
s_branch L_fin
L_C:
s_setprio 1
v_and_b32 v5, 1, v0
v_cmp_eq_u32 vcc, 1, v5
v_mov_b32 v24, 0x0c0c0100
v_mov_b32 v25, 0x01000c0c
v_mov_b32 v26, 0x0c0c0302
v_mov_b32 v27, 0x03020c0c
v_cndmask_b32 v24, v24, v25, vcc
v_cndmask_b32 v26, v26, v27, vcc
v_bfe_u32 v5, v0, 1, 2
v_mov_b32 v25, 0x0c0c0c0c
v_cmp_eq_u32 vcc, 0, v5
s_nop 1
v_cndmask_b32 v8, v25, v24, vcc
v_cndmask_b32 v12, v25, v26, vcc
v_cmp_eq_u32 vcc, 1, v5
s_nop 1
v_cndmask_b32 v9, v25, v24, vcc
v_cndmask_b32 v13, v25, v26, vcc
v_cmp_eq_u32 vcc, 2, v5
s_nop 1
v_cndmask_b32 v10, v25, v24, vcc
v_cndmask_b32 v14, v25, v26, vcc
v_cmp_eq_u32 vcc, 3, v5
s_nop 1
v_cndmask_b32 v11, v25, v24, vcc
v_cndmask_b32 v15, v25, v26, vcc
v_mov_b32 v130, 1
s_waitcnt lgkmcnt(0)
s_lshl_b32 s22, s3, 1
s_sub_u32 s22, s22, 1
s_lshl_b32 s23, s42, 7
s_lshl_b32 s24, s37, 10
s_add_u32 s24, s24, s23
s_lshl_b32 s64, s37, 3
s_add_u32 s64, s64, s41
s_mul_i32 s65, s3, 24
s_add_u32 s64, s64, s65
s_sub_u32 s64, s64, 24
s_mov_b32 s28, s26
s_mov_b32 s29, s27
s_cmp_ge_u32 s64, 97
s_cbranch_scc1 L_CW
s_lshl_b32 s65, s64, 10
s_add_u32 s65, s65, s101
v_lshlrev_b32 v4, 4, v0
buffer_load_dwordx4 v[64:67], v4, s[28:31], s65 offen
L_CW:
s_waitcnt vmcnt(0)
W_4:
ds_read_b64 v[4:5], v7 offset:1024
s_sleep 2
s_sub_u32 s100, s100, 1
s_cbranch_scc1 L_fin
s_waitcnt lgkmcnt(0)
v_cmp_le_u32 vcc, s22, v4
s_cbranch_vccz W_4
L_TC0:
v_readfirstlane_b32 s36, v5
s_add_u32 s32, s36, 1
s_add_u32 s33, s36, 38
s_add_u32 s34, s36, 75
s_add_u32 s35, s36, 112
s_and_b32 s32, s32, 0xff
s_and_b32 s33, s33, 0xff
s_and_b32 s34, s34, 0xff
s_and_b32 s35, s35, 0xff
s_mul_i32 s70, s36, 0x01010101
s_add_u32 s70, s70, 0x3c6ef301
s_mov_b32 s71, s70
s_cmp_le_u32 s3, 3
s_cbranch_scc1 L_C0
v_cmp_le_u32 vcc, 64, v4
s_cbranch_vccnz L_fin
L_Cg:
s_mov_b32 s64, 1
s_atomic_add s64, s[26:27], s24 offset:1024 glc
s_sub_u32 s100, s100, 1
s_cbranch_scc1 L_fin
s_waitcnt lgkmcnt(0)
s_xor_b32 s65, s64, s70
s_lshr_b32 s65, s65, 8
s_cbranch_scc1 L_Cg
s_and_b32 s64, s64, 0xff
s_mul_i32 s64, s64, 3
s_add_u32 s64, s64, s37
s_add_u32 s64, s64, 72
s_cmp_lt_u32 s64, 120
s_cbranch_scc1 L_C0
v_mov_b32 v130, 64
s_mov_b64 exec, 1
ds_add_u32 v7, v130 offset:1024
s_mov_b64 exec, -1
s_branch L_fin
L_C0:
s_mov_b32 s16, s64
s_lshl_b32 s9, s64, 7
s_add_u32 s9, s9, s101
s_add_u32 s17, s9, 819200
s_lshl_b32 s9, s64, 4
s_add_u32 s9, s9, s101
s_lshl_b32 s14, s42, 8
s_mov_b32 s7, 0x20000
s_cmp_lt_u32 s64, 64
s_cbranch_scc0 L_CD
s_and_b32 s67, s64, 48
s_add_u32 s67, s67, s64
s_lshl_b32 s67, s67, 11
s_add_u32 s56, s67, 180224
s_add_u32 s25, s56, s23
s_add_u32 s25, s25, 256
s_add_u32 s24, s25, 32768
s_add_u32 s57, s56, 128
s_add_u32 s58, s56, 32768
s_add_u32 s59, s58, 128
s_mov_b32 s4, s12
s_mov_b32 s5, s13
s_mov_b32 s6, 8388608
s_mov_b32 s11, 13
s_mov_b32 s12, 61440
s_mov_b32 s60, -1
s_mov_b32 s61, 1
s_mov_b32 s72, s32
s_mov_b32 s73, s33
s_mov_b32 s74, s34
s_mov_b32 s75, s35
s_mov_b32 s76, s32
s_mov_b32 s77, s33
s_mov_b32 s78, s34
s_mov_b32 s79, s35
s_mov_b32 s80, 0xff
s_mov_b32 s81, 0xff
s_mov_b64 s[82:83], s[80:81]
s_mov_b64 s[84:85], s[80:81]
s_mov_b64 s[86:87], s[80:81]
v_lshlrev_b32 v131, 4, v2
s_branch L_CE
L_CD:
s_sub_u32 s64, s64, 64
s_lshr_b32 s25, s64, 1
s_lshl_b32 s25, s25, 10
s_add_u32 s25, s25, s23
s_add_u32 s25, s25, 704512
s_add_u32 s24, s25, 16
s_lshl_b32 s56, s64, 12
s_add_u32 s56, s56, 442368
s_add_u32 s57, s56, 2048
s_add_u32 s58, s56, 1024
s_add_u32 s59, s56, 3072
s_mov_b32 s4, s20
s_mov_b32 s5, s21
s_mov_b32 s6, 7340032
s_mov_b32 s11, 14
s_mov_b32 s12, 4096
s_mov_b32 s60, 0xffff
s_and_b32 s61, s64, 7
s_cmp_eq_u32 s61, 3
s_cselect_b32 s61, -1, 0
s_cmp_eq_u32 s64, 31
s_cselect_b32 s61, -1, s61
s_mov_b32 s61, -1
s_mov_b64 s[72:73], s[70:71]
s_mov_b64 s[74:75], s[70:71]
s_mov_b64 s[76:77], s[70:71]
s_mov_b64 s[78:79], s[70:71]
s_mov_b64 s[80:81], -1
s_mov_b32 s82, -1
s_mov_b32 s83, 0
s_mov_b32 s84, s61
s_mov_b32 s85, s61
s_mov_b32 s86, s61
s_mov_b32 s87, 0
s_mov_b32 s61, 0
s_bfe_u32 s83, s64, 0x20001
s_cmp_eq_u32 s83, 1
s_cselect_b32 s83, -1, 0
s_cselect_b32 s60, -1, s60
s_mov_b32 s87, s83
v_lshlrev_b32 v131, 4, v0
L_CE:
s_not_b64 s[88:89], s[72:73]
s_not_b64 s[90:91], s[74:75]
s_not_b64 s[92:93], s[76:77]
s_not_b64 s[94:95], s[78:79]
s_load_dwordx4 s[88:91], s[26:27], s25 glc
s_load_dwordx4 s[92:95], s[26:27], s24 glc
s_lshl_b32 s13, s64, 17
s_add_u32 s13, s13, s14
v_lshlrev_b32 v1, s11, v2
v_add_u32 v1, v1, v3
s_add_u32 s22, s22, 3
v_lshrrev_b32 v5, 4, v0
v_lshl_add_u32 v137, v5, 14, v3
v_mov_b64 v[16:17], 0
v_mov_b64 v[18:19], 0
v_mov_b64 v[20:21], 0
v_mov_b64 v[22:23], 0
v_mov_b64 v[24:25], 0
v_mov_b64 v[26:27], 0
v_mov_b64 v[28:29], 0
v_mov_b64 v[30:31], 0
v_mov_b32 v135, 1
s_mov_b32 s18, 1
W_5:
ds_read_b32 v4, v7 offset:1024
s_sleep 1
s_sub_u32 s100, s100, 1
s_cbranch_scc1 L_fin
s_waitcnt lgkmcnt(4)
v_cmp_le_u32 vcc, s22, v4
s_cbranch_vccz W_5
s_cmp_eq_u32 s18, 2
s_cbranch_scc1 L_C6
s_xor_b64 s[48:49], s[88:89], s[72:73]
s_xor_b64 s[50:51], s[90:91], s[74:75]
s_xor_b64 s[52:53], s[92:93], s[76:77]
s_xor_b64 s[54:55], s[94:95], s[78:79]
s_and_b64 s[48:49], s[48:49], s[80:81]
s_and_b64 s[50:51], s[50:51], s[82:83]
s_and_b64 s[52:53], s[52:53], s[84:85]
s_and_b64 s[54:55], s[54:55], s[86:87]
s_or_b64 s[48:49], s[48:49], s[50:51]
s_or_b64 s[52:53], s[52:53], s[54:55]
s_or_b64 s[48:49], s[48:49], s[52:53]
s_cbranch_scc1 L_C6
s_mov_b32 s18, 2
s_mov_b32 exec_hi, s60
buffer_load_dwordx4 v[16:19], v131, s[28:31], s56 offen sc1
buffer_load_dwordx4 v[20:23], v131, s[28:31], s57 offen sc1
s_cmp_eq_u32 s61, 0
s_cbranch_scc1 X_6
buffer_load_dwordx4 v[24:27], v131, s[28:31], s58 offen sc1
buffer_load_dwordx4 v[28:31], v131, s[28:31], s59 offen sc1
X_6:
s_mov_b32 exec_hi, -1
L_C6:
buffer_load_dwordx4 v[64:67], v1, s[4:7], s13 offen offset:0 nt
buffer_load_dwordx4 v[68:71], v1, s[4:7], s13 offen offset:128 nt
buffer_load_dwordx4 v[72:75], v1, s[4:7], s13 offen offset:2048 nt
buffer_load_dwordx4 v[76:79], v1, s[4:7], s13 offen offset:2176 nt
s_add_u32 s13, s13, 4096
buffer_load_dwordx4 v[80:83], v1, s[4:7], s13 offen offset:0 nt
buffer_load_dwordx4 v[84:87], v1, s[4:7], s13 offen offset:128 nt
buffer_load_dwordx4 v[88:91], v1, s[4:7], s13 offen offset:2048 nt
buffer_load_dwordx4 v[92:95], v1, s[4:7], s13 offen offset:2176 nt
s_add_u32 s13, s13, s12
s_add_u32 s22, s22, 1
W_7:
ds_read_b32 v4, v7 offset:1024
s_sleep 1
s_sub_u32 s100, s100, 1
s_cbranch_scc1 L_fin
s_waitcnt lgkmcnt(4)
v_cmp_le_u32 vcc, s22, v4
s_cbranch_vccz W_7
s_cmp_eq_u32 s18, 2
s_cbranch_scc1 L_C4
s_waitcnt lgkmcnt(0)
s_xor_b64 s[48:49], s[88:89], s[72:73]
s_xor_b64 s[50:51], s[90:91], s[74:75]
s_xor_b64 s[52:53], s[92:93], s[76:77]
s_xor_b64 s[54:55], s[94:95], s[78:79]
s_and_b64 s[48:49], s[48:49], s[80:81]
s_and_b64 s[50:51], s[50:51], s[82:83]
s_and_b64 s[52:53], s[52:53], s[84:85]
s_and_b64 s[54:55], s[54:55], s[86:87]
s_or_b64 s[48:49], s[48:49], s[50:51]
s_or_b64 s[52:53], s[52:53], s[54:55]
s_or_b64 s[48:49], s[48:49], s[52:53]
s_cbranch_scc1 L_C4
s_mov_b32 s18, 0
s_mov_b32 exec_hi, s60
buffer_load_dwordx4 v[16:19], v131, s[28:31], s56 offen sc1
buffer_load_dwordx4 v[20:23], v131, s[28:31], s57 offen sc1
s_cmp_eq_u32 s61, 0
s_cbranch_scc1 X_8
buffer_load_dwordx4 v[24:27], v131, s[28:31], s58 offen sc1
buffer_load_dwordx4 v[28:31], v131, s[28:31], s59 offen sc1
X_8:
s_mov_b32 exec_hi, -1
L_C4:
buffer_load_dwordx4 v[96:99], v1, s[4:7], s13 offen offset:0 nt
buffer_load_dwordx4 v[100:103], v1, s[4:7], s13 offen offset:128 nt
buffer_load_dwordx4 v[104:107], v1, s[4:7], s13 offen offset:2048 nt
buffer_load_dwordx4 v[108:111], v1, s[4:7], s13 offen offset:2176 nt
s_add_u32 s13, s13, 4096
buffer_load_dwordx4 v[112:115], v1, s[4:7], s13 offen offset:0 nt
buffer_load_dwordx4 v[116:119], v1, s[4:7], s13 offen offset:128 nt
buffer_load_dwordx4 v[120:123], v1, s[4:7], s13 offen offset:2048 nt
buffer_load_dwordx4 v[124:127], v1, s[4:7], s13 offen offset:2176 nt
s_lshl_b32 s14, s3, 7
v_lshlrev_b32 v133, 1, v5
v_add3_u32 v133, v133, v3, s14
v_and_b32 v5, 8, v0
v_add_u32 v133, v133, v5
v_lshl_add_u32 v134, v2, 4, s14
v_lshrrev_b32 v5, 4, v0
v_lshlrev_b32 v136, 7, v3
v_lshl_add_u32 v136, v5, 14, v136
s_cmp_eq_u32 s18, 1
s_cbranch_scc1 L_V4
s_waitcnt lgkmcnt(0)
s_branch L_V7
L_V4:
v_mov_b32 v135, 0
s_load_dwordx4 s[88:91], s[26:27], s25 glc
s_load_dwordx4 s[92:95], s[26:27], s24 glc
s_waitcnt lgkmcnt(0)
s_xor_b64 s[48:49], s[88:89], s[72:73]
s_xor_b64 s[50:51], s[90:91], s[74:75]
s_xor_b64 s[52:53], s[92:93], s[76:77]
s_xor_b64 s[54:55], s[94:95], s[78:79]
s_and_b64 s[48:49], s[48:49], s[80:81]
s_and_b64 s[50:51], s[50:51], s[82:83]
s_and_b64 s[52:53], s[52:53], s[84:85]
s_and_b64 s[54:55], s[54:55], s[86:87]
s_or_b64 s[48:49], s[48:49], s[50:51]
s_or_b64 s[52:53], s[52:53], s[54:55]
s_or_b64 s[48:49], s[48:49], s[52:53]
s_cbranch_scc1 L_V4b
s_mov_b32 exec_hi, s60
buffer_load_dwordx4 v[16:19], v131, s[28:31], s56 offen sc1
buffer_load_dwordx4 v[20:23], v131, s[28:31], s57 offen sc1
s_cmp_eq_u32 s61, 0
s_cbranch_scc1 X_9
buffer_load_dwordx4 v[24:27], v131, s[28:31], s58 offen sc1
buffer_load_dwordx4 v[28:31], v131, s[28:31], s59 offen sc1
X_9:
s_mov_b32 exec_hi, -1
s_waitcnt vmcnt(12)
s_mov_b64 exec, 1
ds_add_u32 v7, v130 offset:1024
s_mov_b64 exec, -1
s_waitcnt vmcnt(4)
s_mov_b64 exec, 1
ds_add_u32 v7, v130 offset:1024
s_mov_b64 exec, -1
s_branch L_V6
L_V4b:
s_load_dwordx4 s[88:91], s[26:27], s25 glc
s_load_dwordx4 s[92:95], s[26:27], s24 glc
s_waitcnt vmcnt(10)
s_mov_b64 exec, 1
ds_add_u32 v7, v130 offset:1024
s_mov_b64 exec, -1
s_waitcnt lgkmcnt(0)
s_xor_b64 s[48:49], s[88:89], s[72:73]
s_xor_b64 s[50:51], s[90:91], s[74:75]
s_xor_b64 s[52:53], s[92:93], s[76:77]
s_xor_b64 s[54:55], s[94:95], s[78:79]
s_and_b64 s[48:49], s[48:49], s[80:81]
s_and_b64 s[50:51], s[50:51], s[82:83]
s_and_b64 s[52:53], s[52:53], s[84:85]
s_and_b64 s[54:55], s[54:55], s[86:87]
s_or_b64 s[48:49], s[48:49], s[50:51]
s_or_b64 s[52:53], s[52:53], s[54:55]
s_or_b64 s[48:49], s[48:49], s[52:53]
s_cbranch_scc1 L_V5
s_mov_b32 exec_hi, s60
buffer_load_dwordx4 v[16:19], v131, s[28:31], s56 offen sc1
buffer_load_dwordx4 v[20:23], v131, s[28:31], s57 offen sc1
s_cmp_eq_u32 s61, 0
s_cbranch_scc1 X_10
buffer_load_dwordx4 v[24:27], v131, s[28:31], s58 offen sc1
buffer_load_dwordx4 v[28:31], v131, s[28:31], s59 offen sc1
X_10:
s_mov_b32 exec_hi, -1
s_waitcnt vmcnt(4)
s_mov_b64 exec, 1
ds_add_u32 v7, v130 offset:1024
s_mov_b64 exec, -1
s_branch L_V6
L_V5:
s_load_dwordx4 s[88:91], s[26:27], s25 glc
s_load_dwordx4 s[92:95], s[26:27], s24 glc
s_sub_u32 s100, s100, 1
s_cbranch_scc1 L_fin
s_waitcnt vmcnt(2)
s_mov_b64 exec, 1
ds_add_u32 v7, v130 offset:1024
s_mov_b64 exec, -1
s_branch L_V2
L_V1:
s_sleep 1
s_load_dwordx4 s[88:91], s[26:27], s25 glc
s_load_dwordx4 s[92:95], s[26:27], s24 glc
s_sub_u32 s100, s100, 1
s_cbranch_scc1 L_fin
L_V2:
s_waitcnt lgkmcnt(0)
s_xor_b64 s[48:49], s[88:89], s[72:73]
s_xor_b64 s[50:51], s[90:91], s[74:75]
s_xor_b64 s[52:53], s[92:93], s[76:77]
s_xor_b64 s[54:55], s[94:95], s[78:79]
s_and_b64 s[48:49], s[48:49], s[80:81]
s_and_b64 s[50:51], s[50:51], s[82:83]
s_and_b64 s[52:53], s[52:53], s[84:85]
s_and_b64 s[54:55], s[54:55], s[86:87]
s_or_b64 s[48:49], s[48:49], s[50:51]
s_or_b64 s[52:53], s[52:53], s[54:55]
s_or_b64 s[48:49], s[48:49], s[52:53]
s_cbranch_scc1 L_V1
s_mov_b32 exec_hi, s60
buffer_load_dwordx4 v[16:19], v131, s[28:31], s56 offen sc1
buffer_load_dwordx4 v[20:23], v131, s[28:31], s57 offen sc1
s_cmp_eq_u32 s61, 0
s_cbranch_scc1 X_11
buffer_load_dwordx4 v[24:27], v131, s[28:31], s58 offen sc1
buffer_load_dwordx4 v[28:31], v131, s[28:31], s59 offen sc1
X_11:
s_mov_b32 exec_hi, -1
L_V6:
v_mov_b32 v130, 0
s_mov_b32 s18, 1
L_V7:
s_cmp_eq_u32 s11, 14
s_cbranch_scc1 L_V8
s_and_b32 s20, s88, 0xffffff00
s_and_b32 s21, s92, 0xffffff00
v_mov_b32 v32, s20
v_max_f32 v34, s21, v32
v_sub_f32 v32, v32, v34
v_sub_f32 v33, s21, v34
v_mul_f32 v32, 0x3fb8aa3b, v32
v_mul_f32 v33, 0x3fb8aa3b, v33
v_exp_f32 v32, v32
v_exp_f32 v33, v33
s_xor_b32 s20, s89, s33
s_xor_b32 s21, s93, s33
v_mul_f32 v34, s20, v32
v_fmac_f32 v34, s21, v33
v_rcp_f32 v34, v34
s_nop 0
v_mul_f32 v32, v32, v34
v_mul_f32 v33, v33, v34
L_V8:
s_mov_b32 exec_hi, s60
s_waitcnt vmcnt(16)
s_cmp_eq_u32 s18, 2
s_cbranch_scc1 L_V9
s_waitcnt vmcnt(8)
s_cmp_eq_u32 s18, 0
s_cbranch_scc0 L_V10
s_mov_b64 exec, 1
ds_add_u32 v7, v135 offset:1024
v_mov_b32 v135, 0
s_mov_b32 exec_lo, -1
s_mov_b32 exec_hi, s60
s_branch L_V9
L_V10:
s_waitcnt vmcnt(0)
L_V9:
v_xor_b32 v16, s32, v16
v_xor_b32 v17, s33, v17
v_xor_b32 v18, s34, v18
v_xor_b32 v19, s35, v19
v_xor_b32 v20, s32, v20
v_xor_b32 v21, s33, v21
v_xor_b32 v22, s34, v22
v_xor_b32 v23, s35, v23
v_or3_b32 v5, v16, v17, v18
v_or3_b32 v4, v19, v20, v21
v_or3_b32 v5, v5, v22, v23
s_cmp_eq_u32 s61, 0
s_cbranch_scc1 L_V11
v_xor_b32 v24, s32, v24
v_xor_b32 v25, s33, v25
v_xor_b32 v26, s34, v26
v_xor_b32 v27, s35, v27
v_xor_b32 v28, s32, v28
v_xor_b32 v29, s33, v29
v_xor_b32 v30, s34, v30
v_xor_b32 v31, s35, v31
v_or3_b32 v5, v5, v24, v25
v_or3_b32 v4, v4, v26, v27
v_or3_b32 v5, v5, v28, v29
v_or3_b32 v4, v4, v30, v31
L_V11:
v_bitop3_b32 v5, v5, v4, v6 bitop3:0xa8
v_cmp_ne_u32 vcc, 0, v5
s_mov_b32 exec_hi, -1
s_cbranch_vccnz L_V5
s_cmp_eq_u32 s11, 14
s_cbranch_scc1 L_C3
v_pk_mul_f32 v[16:17], v[16:17], v[32:33] op_sel_hi:[1,0]
v_pk_mul_f32 v[18:19], v[18:19], v[32:33] op_sel_hi:[1,0]
v_pk_mul_f32 v[20:21], v[20:21], v[32:33] op_sel_hi:[1,0]
v_pk_mul_f32 v[22:23], v[22:23], v[32:33] op_sel_hi:[1,0]
v_fmac_f32 v16, v24, v33
v_fmac_f32 v17, v25, v33
v_fmac_f32 v18, v26, v33
v_fmac_f32 v19, v27, v33
v_fmac_f32 v20, v28, v33
v_fmac_f32 v21, v29, v33
v_fmac_f32 v22, v30, v33
v_fmac_f32 v23, v31, v33
v_cvt_pk_bf16_f32 v16, v16, v17
v_cvt_pk_bf16_f32 v17, v18, v19
v_cvt_pk_bf16_f32 v18, v20, v21
v_cvt_pk_bf16_f32 v19, v22, v23
s_branch L_C5
L_C3:
s_cmp_eq_u32 s61, 0
s_cbranch_scc1 L_C3b
v_pk_add_f32 v[16:17], v[16:17], v[24:25]
v_pk_add_f32 v[18:19], v[18:19], v[26:27]
v_pk_add_f32 v[20:21], v[20:21], v[28:29]
v_pk_add_f32 v[22:23], v[22:23], v[30:31]
L_C3b:
v_permlane32_swap_b32 v16, v18
v_permlane32_swap_b32 v17, v19
v_permlane32_swap_b32 v20, v22
v_permlane32_swap_b32 v21, v23
v_pk_add_f32 v[16:17], v[16:17], v[18:19]
v_pk_add_f32 v[20:21], v[20:21], v[22:23]
s_nop 0
v_permlane16_swap_b32 v16, v17
v_permlane16_swap_b32 v20, v21
v_add_f32 v16, v16, v17
v_add_f32 v20, v20, v21
v_cvt_pk_bf16_f32 v20, v16, v20
v_lshlrev_b32 v16, 16, v20
v_and_b32 v20, 0xffff0000, v20
v_mul_f32 v16, 0xbfb8aa3b, v16
v_exp_f32 v16, v16
s_nop 0
v_add_f32 v16, 1.0, v16
v_rcp_f32 v16, v16
s_nop 0
v_cvt_pk_bf16_f32 v16, v16, v16
v_and_b32 v16, 0xffff0000, v16
v_mul_f32 v16, v16, v20
v_cvt_pk_bf16_f32 v16, v16, v16
ds_write_b16 v133, v16 offset:2048
ds_read_b128 v[16:19], v134 offset:2048
s_waitcnt lgkmcnt(0)
L_C5:
v_perm_b32 v24, v16, v16, v8
v_perm_b32 v25, v16, v16, v9
v_perm_b32 v26, v16, v16, v10
v_perm_b32 v27, v16, v16, v11
v_perm_b32 v28, v16, v16, v12
v_perm_b32 v29, v16, v16, v13
s_waitcnt vmcnt(15)
v_mfma_f32_16x16x32_bf16 v[56:59], v[24:27], v[64:67], 0
v_perm_b32 v30, v16, v16, v14
v_perm_b32 v31, v16, v16, v15
s_waitcnt vmcnt(14)
v_mfma_f32_16x16x32_bf16 v[60:63], v[24:27], v[68:71], 0
v_perm_b32 v32, v17, v17, v8
v_perm_b32 v33, v17, v17, v9
s_waitcnt vmcnt(13)
v_mfma_f32_16x16x32_bf16 v[56:59], v[28:31], v[72:75], v[56:59]
v_perm_b32 v34, v17, v17, v10
v_perm_b32 v35, v17, v17, v11
s_waitcnt vmcnt(12)
v_mfma_f32_16x16x32_bf16 v[60:63], v[28:31], v[76:79], v[60:63]
v_perm_b32 v36, v17, v17, v12
v_perm_b32 v37, v17, v17, v13
s_waitcnt vmcnt(11)
v_mfma_f32_16x16x32_bf16 v[56:59], v[32:35], v[80:83], v[56:59]
v_perm_b32 v38, v17, v17, v14
v_perm_b32 v39, v17, v17, v15
s_waitcnt vmcnt(10)
s_mov_b64 exec, 1
ds_add_u32 v7, v135 offset:1024
s_mov_b64 exec, -1
v_mfma_f32_16x16x32_bf16 v[60:63], v[32:35], v[84:87], v[60:63]
v_perm_b32 v40, v18, v18, v8
v_perm_b32 v41, v18, v18, v9
s_waitcnt vmcnt(9)
v_mfma_f32_16x16x32_bf16 v[56:59], v[36:39], v[88:91], v[56:59]
v_perm_b32 v42, v18, v18, v10
v_perm_b32 v43, v18, v18, v11
s_waitcnt vmcnt(8)
v_mfma_f32_16x16x32_bf16 v[60:63], v[36:39], v[92:95], v[60:63]
v_perm_b32 v44, v18, v18, v12
v_perm_b32 v45, v18, v18, v13
s_waitcnt vmcnt(7)
v_mfma_f32_16x16x32_bf16 v[56:59], v[40:43], v[96:99], v[56:59]
v_perm_b32 v46, v18, v18, v14
v_perm_b32 v47, v18, v18, v15
s_waitcnt vmcnt(6)
v_mfma_f32_16x16x32_bf16 v[60:63], v[40:43], v[100:103], v[60:63]
v_perm_b32 v48, v19, v19, v8
v_perm_b32 v49, v19, v19, v9
s_waitcnt vmcnt(5)
v_mfma_f32_16x16x32_bf16 v[56:59], v[44:47], v[104:107], v[56:59]
v_perm_b32 v50, v19, v19, v10
v_perm_b32 v51, v19, v19, v11
s_waitcnt vmcnt(4)
v_mfma_f32_16x16x32_bf16 v[60:63], v[44:47], v[108:111], v[60:63]
v_perm_b32 v52, v19, v19, v12
v_perm_b32 v53, v19, v19, v13
s_waitcnt vmcnt(3)
v_mfma_f32_16x16x32_bf16 v[56:59], v[48:51], v[112:115], v[56:59]
v_perm_b32 v54, v19, v19, v14
v_perm_b32 v55, v19, v19, v15
s_waitcnt vmcnt(2)
s_mov_b64 exec, 1
ds_add_u32 v7, v130 offset:1024
s_mov_b64 exec, -1
v_mfma_f32_16x16x32_bf16 v[60:63], v[48:51], v[116:119], v[60:63]
s_waitcnt vmcnt(1)
v_mfma_f32_16x16x32_bf16 v[56:59], v[52:55], v[120:123], v[56:59]
s_waitcnt vmcnt(0)
v_mfma_f32_16x16x32_bf16 v[60:63], v[52:55], v[124:127], v[60:63]
s_nop 7
v_permlane32_swap_b32 v56, v60
v_permlane32_swap_b32 v57, v61
v_permlane32_swap_b32 v58, v62
v_permlane32_swap_b32 v59, v63
v_add_f32_dpp v56, v60, v56 row_ror:8 row_mask:0xf bank_mask:0xf
v_add_f32_dpp v57, v61, v57 row_ror:8 row_mask:0xf bank_mask:0xf
v_add_f32_dpp v58, v62, v58 row_ror:8 row_mask:0xf bank_mask:0xf
v_add_f32_dpp v59, v63, v59 row_ror:8 row_mask:0xf bank_mask:0xf
v_bfi_b32 v56, v6, s32, v56
v_bfi_b32 v57, v6, s33, v57
v_bfi_b32 v58, v6, s34, v58
v_bfi_b32 v59, v6, s35, v59
s_mov_b32 exec_lo, 0x00ff00ff
s_mov_b32 exec_hi, 0x00ff00ff
buffer_store_dwordx4 v[56:59], v136, s[28:31], s9 offen
s_barrier
buffer_store_dwordx4 v[56:59], v137, s[28:31], s17 offen sc1
s_branch L_fin
L_Cend:
L_A2:
s_load_dword s36, s[26:27], 0
s_mov_b32 s28, s26
s_mov_b32 s29, s27
s_lshl_b32 s53, s40, 3
s_add_u32 s53, s53, s3
s_lshl_b32 s55, s53, 4
s_and_b32 s56, s43, 3
s_add_u32 s55, s55, s56
s_lshl_b32 s55, s55, 7
s_add_u32 s55, s55, 16384
s_load_dword s72, s[26:27], s55 glc
v_lshlrev_b32 v134, 4, v0
v_and_b32 v10, 7, v8
v_lshlrev_b32 v135, 4, v10
s_lshl_b32 s56, s41, 12
s_lshl_b32 s57, s3, 10
s_add_u32 s56, s56, s57
s_add_u32 s56, s56, s101
s_add_u32 s56, s56, 65536
s_lshl_b32 s57, s41, 7
s_add_u32 s57, s57, s101
s_add_u32 s57, s57, 98304
s_lshl_b32 s58, s38, 12
s_lshl_b32 s59, s3, 10
s_add_u32 s58, s58, s59
s_add_u32 s58, s58, 180224
s_cmp_eq_u32 s3, 1
s_cbranch_scc0 L_A3
s_lshl_b32 s58, s39, 10
s_add_u32 s58, s58, 704256
L_A3:
s_cmp_ge_u32 s3, 3
s_cbranch_scc1 L_A3b
s_load_dword s88, s[26:27], s58 offset:256 glc
s_load_dword s89, s[26:27], s58 offset:384 glc
s_load_dword s90, s[26:27], s58 offset:512 glc
s_load_dword s91, s[26:27], s58 offset:640 glc
s_load_dword s92, s[26:27], s58 offset:768 glc
s_load_dword s93, s[26:27], s58 offset:896 glc
s_load_dword s94, s[26:27], s58 offset:1024 glc
s_load_dword s95, s[26:27], s58 offset:1152 glc
L_A3b:
v_lshlrev_b32 v5, 1, v10
v_xor_b32 v5, v5, v9
v_lshlrev_b32 v5, 4, v5
v_lshl_add_u32 v2, v8, 8, v5
v_add_u32 v2, s66, v2
v_lshrrev_b32 v5, 2, v8
v_lshl_add_u32 v5, v9, 2, v5
v_and_b32 v11, 7, v5
v_lshlrev_b32 v11, 5, v11
v_and_b32 v12, 3, v8
v_lshl_add_u32 v11, v12, 3, v11
v_lshl_add_u32 v11, v5, 8, v11
s_add_u32 s67, s66, 65536
v_add_u32 v11, s67, v11
s_add_u32 m0, s66, 65536
s_waitcnt vmcnt(3)
buffer_load_dwordx4 v3, s[48:51], s64 offen offset:0 nt lds
s_waitcnt vmcnt(3)
buffer_load_dwordx4 v4, s[48:51], s82 offen offset:1024 nt lds
s_lshl_b32 s67, s41, 3
s_add_u32 s67, s67, s3
s_cmp_eq_u32 s67, 3
s_cbranch_scc0 L_A5
s_waitcnt lgkmcnt(0)
s_add_u32 s32, s36, 1
s_add_u32 s33, s36, 38
s_add_u32 s34, s36, 75
s_add_u32 s35, s36, 112
s_and_b32 s32, s32, 0xff
s_and_b32 s33, s33, 0xff
s_and_b32 s34, s34, 0xff
s_and_b32 s35, s35, 0xff
s_mul_i32 s70, s36, 0x01010101
s_add_u32 s70, s70, 0x3c6ef301
s_mov_b32 s71, s70
s_and_b32 s67, s70, 0xffffff00
v_mov_b32 v5, s67
s_lshl_b32 s67, s42, 7
v_lshlrev_b32 v12, 10, v0
s_mov_b64 exec, 7
buffer_store_dword v5, v12, s[28:31], s67 offen offset:1024 sc1
s_mov_b64 exec, -1
L_A5:
v_lshrrev_b32 v13, 5, v0
v_and_b32 v14, 31, v0
v_lshlrev_b32 v14, 4, v14
v_lshl_add_u32 v1, v13, 14, v14
s_lshl_b32 s52, s53, 9
s_add_u32 s52, s52, 81920
s_add_u32 s54, s52, 0x8000
s_add_u32 s53, s52, 0x10000
v_and_b32 v12, 1, v9
v_lshlrev_b32 v12, 7, v12
v_lshl_add_u32 v12, v10, 4, v12
v_lshrrev_b32 v133, 3, v8
v_lshl_add_u32 v12, v133, 3, v12
v_lshl_add_u32 v12, v13, 2, v12
s_mul_i32 s67, s3, 288
s_add_u32 s67, s67, 131072
v_add_u32 v12, s67, v12
v_mul_u32_u24 v15, 288, v10
v_lshl_add_u32 v15, v9, 4, v15
v_add_u32 v15, 131072, v15
v_mul_u32_u24 v128, 528, v10
v_lshl_add_u32 v128, v9, 4, v128
v_lshl_add_u32 v128, v133, 6, v128
v_add_u32 v128, s66, v128
s_lshl_b32 s67, s3, 3
s_add_u32 s67, s67, 133376
v_lshl_add_u32 v129, v10, 6, s67
s_mul_i32 s67, s3, 528
v_lshl_add_u32 v130, v13, 15, v14
v_add_u32 v130, s67, v130
s_lshl_b32 s67, s3, 6
s_add_u32 s67, s67, 133376
v_lshl_add_u32 v131, v13, 5, s67
s_lshl_b32 s67, s3, 12
s_lshl_b32 s69, s41, 8
s_add_u32 s67, s67, s69
s_add_u32 s67, s67, s101
s_add_u32 s67, s67, 65536
v_lshlrev_b32 v5, 4, v8
v_lshl_add_u32 v132, v9, 11, v5
v_add_u32 v132, s67, v132
s_lshl_b32 s67, s3, 7
s_lshl_b32 s69, s41, 4
s_add_u32 s67, s67, s69
s_add_u32 s67, s67, s101
s_add_u32 s67, s67, 98304
s_mov_b32 exec_lo, 0
v_mov_b32 v132, s67
s_mov_b32 exec_lo, -1
v_mov_b32 v136, v134
s_mov_b64 exec, 0xff0000
v_lshlrev_b32 v136, 7, v8
v_add_u32 v136, 256, v136
s_mov_b64 exec, -1
v_xor_b32 v140, 32, v11
v_xor_b32 v141, 64, v11
v_xor_b32 v142, 96, v11
v_xor_b32 v143, 128, v11
v_xor_b32 v144, 160, v11
v_xor_b32 v145, 192, v11
v_xor_b32 v146, 224, v11
v_mov_b32 v112, 0
v_mov_b32 v113, 0
v_mov_b32 v114, 0
v_mov_b32 v115, 0
v_mov_b32 v116, 0
v_mov_b32 v117, 0
v_mov_b32 v118, 0
v_mov_b32 v119, 0
v_mov_b32 v122, 0
v_mov_b32 v123, 0
s_mov_b32 s59, 819200
s_mov_b32 s60, 0x3db504f3
s_mov_b32 s62, 0x3fb8aa3b
s_waitcnt vmcnt(3)
buffer_load_dwordx4 v3, s[48:51], s84 offen offset:2048 nt lds
s_waitcnt vmcnt(3)
buffer_load_dwordx4 v4, s[48:51], s86 offen offset:3072 nt lds
s_add_u32 m0, s66, 69632
s_waitcnt vmcnt(3)
buffer_load_dwordx4 v3, s[48:51], s65 offen offset:0 nt lds
s_waitcnt vmcnt(3)
buffer_load_dwordx4 v4, s[48:51], s83 offen offset:1024 nt lds
s_waitcnt vmcnt(3)
buffer_load_dwordx4 v3, s[48:51], s85 offen offset:2048 nt lds
s_waitcnt vmcnt(3)
buffer_load_dwordx4 v4, s[48:51], s87 offen offset:3072 nt lds
s_waitcnt lgkmcnt(0)
s_add_u32 s32, s36, 1
s_add_u32 s33, s36, 38
s_add_u32 s34, s36, 75
s_add_u32 s35, s36, 112
s_and_b32 s32, s32, 0xff
s_and_b32 s33, s33, 0xff
s_and_b32 s34, s34, 0xff
s_and_b32 s35, s35, 0xff
s_mul_i32 s70, s36, 0x01010101
s_add_u32 s70, s70, 0x3c6ef301
s_mov_b32 s71, s70
v_mov_b64 v[84:85], 0
v_mov_b64 v[86:87], 0
ds_read_b128 v[16:19], v2
ds_read_b128 v[32:35], v2 offset:4096
v_xor_b32 v5, 64, v2
ds_read_b128 v[20:23], v5
ds_read_b128 v[36:39], v5 offset:4096
v_xor_b32 v5, 128, v2
ds_read_b128 v[24:27], v5
ds_read_b128 v[40:43], v5 offset:4096
v_xor_b32 v5, 192, v2
ds_read_b128 v[28:31], v5
ds_read_b128 v[44:47], v5 offset:4096
s_branch H_13
H_12:
s_sleep 2
H_13:
s_load_dwordx8 s[72:79], s[26:27], s55 glc
s_sub_u32 s100, s100, 1
s_cbranch_scc1 L_fin
s_waitcnt lgkmcnt(0)
s_xor_b64 s[72:73], s[72:73], s[70:71]
s_xor_b64 s[74:75], s[74:75], s[70:71]
s_xor_b64 s[76:77], s[76:77], s[70:71]
s_or_b64 s[72:73], s[72:73], s[74:75]
s_or_b64 s[72:73], s[72:73], s[76:77]
s_cbranch_scc1 H_12
buffer_load_dwordx4 v[80:83], v1, s[28:31], s52 offen sc1
s_mov_b32 exec_hi, 0
buffer_load_dwordx4 v[84:87], v1, s[28:31], s54 offen sc1
s_mov_b32 exec_hi, -1
L_TA0:
s_waitcnt vmcnt(2)
ds_read_b64_tr_b16 v[48:49], v11
ds_read_b64_tr_b16 v[50:51], v11 offset:4096
ds_read_b64_tr_b16 v[52:53], v140
ds_read_b64_tr_b16 v[54:55], v140 offset:4096
ds_read_b64_tr_b16 v[56:57], v141
ds_read_b64_tr_b16 v[58:59], v141 offset:4096
ds_read_b64_tr_b16 v[60:61], v142
ds_read_b64_tr_b16 v[62:63], v142 offset:4096
ds_read_b64_tr_b16 v[64:65], v143
ds_read_b64_tr_b16 v[66:67], v143 offset:4096
ds_read_b64_tr_b16 v[68:69], v144
ds_read_b64_tr_b16 v[70:71], v144 offset:4096
ds_read_b64_tr_b16 v[72:73], v145
ds_read_b64_tr_b16 v[74:75], v145 offset:4096
ds_read_b64_tr_b16 v[76:77], v146
ds_read_b64_tr_b16 v[78:79], v146 offset:4096
s_mov_b32 exec_hi, 0
s_waitcnt vmcnt(0)
v_xor_b32 v84, s32, v84
v_xor_b32 v85, s33, v85
v_xor_b32 v86, s34, v86
v_xor_b32 v87, s35, v87
s_mov_b32 exec_hi, -1
v_xor_b32 v80, s32, v80
v_xor_b32 v81, s33, v81
v_xor_b32 v82, s34, v82
v_xor_b32 v83, s35, v83
v_or3_b32 v5, v84, v85, v86
v_or3_b32 v92, v87, v80, v81
v_or3_b32 v5, v5, v82, v83
v_pk_add_f32 v[80:81], v[80:81], v[84:85]
v_pk_add_f32 v[82:83], v[82:83], v[86:87]
v_bitop3_b32 v5, v5, v92, v6 bitop3:0xa8
v_cmp_ne_u32 vcc, 0, v5
s_cbranch_vccnz H_12
v_permlane32_swap_b32 v80, v82
v_permlane32_swap_b32 v81, v83
v_pk_add_f32 v[80:81], v[80:81], v[82:83]
v_cvt_pk_bf16_f32 v80, v80, v81
ds_write_b32 v12, v80
s_waitcnt lgkmcnt(0)
s_barrier
ds_read_b128 v[80:83], v15 offset:0
ds_read_b128 v[84:87], v15 offset:64
ds_read_b128 v[88:91], v15 offset:128
ds_read_b128 v[92:95], v15 offset:192
s_waitcnt lgkmcnt(3)
v_mfma_f32_16x16x32_bf16 v[96:99], v[16:19], v[80:83], 0
v_mfma_f32_16x16x32_bf16 v[100:103], v[32:35], v[80:83], 0
s_waitcnt lgkmcnt(2)
v_mfma_f32_16x16x32_bf16 v[96:99], v[20:23], v[84:87], v[96:99]
v_mfma_f32_16x16x32_bf16 v[100:103], v[36:39], v[84:87], v[100:103]
s_waitcnt lgkmcnt(1)
v_mfma_f32_16x16x32_bf16 v[96:99], v[24:27], v[88:91], v[96:99]
v_mfma_f32_16x16x32_bf16 v[100:103], v[40:43], v[88:91], v[100:103]
s_waitcnt lgkmcnt(0)
v_mfma_f32_16x16x32_bf16 v[96:99], v[28:31], v[92:95], v[96:99]
v_mfma_f32_16x16x32_bf16 v[100:103], v[44:47], v[92:95], v[100:103]
s_nop 7
v_mov_b32_dpp v96, v100 quad_perm:[0,1,2,3] row_mask:0xf bank_mask:0xc
v_mov_b32_dpp v97, v101 quad_perm:[0,1,2,3] row_mask:0xf bank_mask:0xc
v_mov_b32_dpp v98, v102 quad_perm:[0,1,2,3] row_mask:0xf bank_mask:0xc
v_mov_b32_dpp v99, v103 quad_perm:[0,1,2,3] row_mask:0xf bank_mask:0xc
v_cvt_pk_bf16_f32 v104, v96, v97
v_cvt_pk_bf16_f32 v105, v98, v99
v_lshlrev_b32 v96, 16, v104
v_and_b32 v97, 0xffff0000, v104
v_lshlrev_b32 v98, 16, v105
v_and_b32 v99, 0xffff0000, v105
v_pk_mul_f32 v[96:97], v[96:97], s[60:61] op_sel_hi:[1,0]
v_pk_mul_f32 v[98:99], v[98:99], s[60:61] op_sel_hi:[1,0]
v_cvt_pk_bf16_f32 v104, v96, v97
v_cvt_pk_bf16_f32 v105, v98, v99
v_lshlrev_b32 v96, 16, v104
v_and_b32 v97, 0xffff0000, v104
v_lshlrev_b32 v98, 16, v105
v_and_b32 v99, 0xffff0000, v105
v_max3_f32 v108, v96, v97, v98
v_max_f32 v108, v108, v99
s_nop 1
v_max_f32_dpp v108, v108, v108 row_ror:8 row_mask:0xf bank_mask:0xf
v_mov_b32 v5, v108
s_nop 1
v_permlane16_swap_b32 v108, v5
v_max_f32 v108, v108, v5
v_mov_b32 v5, v108
s_nop 1
v_permlane32_swap_b32 v108, v5
v_max_f32 v108, v108, v5
v_pk_add_f32 v[96:97], v[96:97], v[108:109] op_sel_hi:[1,0] neg_lo:[0,1] neg_hi:[0,1]
v_pk_add_f32 v[98:99], v[98:99], v[108:109] op_sel_hi:[1,0] neg_lo:[0,1] neg_hi:[0,1]
v_pk_mul_f32 v[96:97], v[96:97], s[62:63] op_sel_hi:[1,0]
v_pk_mul_f32 v[98:99], v[98:99], s[62:63] op_sel_hi:[1,0]
v_exp_f32 v96, v96
v_exp_f32 v97, v97
v_exp_f32 v98, v98
v_exp_f32 v99, v99
v_cvt_pk_bf16_f32 v104, v96, v97
v_cvt_pk_bf16_f32 v105, v98, v99
v_pk_add_f32 v[96:97], v[96:97], v[98:99]
v_add_f32 v109, v96, v97
v_mov_b32_dpp v112, v104 quad_perm:[0,1,2,3] row_mask:0xf bank_mask:0x3
v_mov_b32_dpp v113, v105 quad_perm:[0,1,2,3] row_mask:0xf bank_mask:0x3
v_mov_b32_dpp v114, v104 row_ror:8 row_mask:0xf bank_mask:0x3
v_mov_b32_dpp v115, v105 row_ror:8 row_mask:0xf bank_mask:0x3
v_mov_b32_dpp v116, v104 row_ror:8 row_mask:0xf bank_mask:0xc
v_mov_b32_dpp v117, v105 row_ror:8 row_mask:0xf bank_mask:0xc
v_mfma_f32_16x16x32_bf16 v[16:19], v[48:51], v[112:115], 0
v_mov_b32_dpp v118, v104 quad_perm:[0,1,2,3] row_mask:0xf bank_mask:0xc
v_mov_b32_dpp v119, v105 quad_perm:[0,1,2,3] row_mask:0xf bank_mask:0xc
v_mfma_f32_16x16x32_bf16 v[20:23], v[56:59], v[112:115], 0
v_add_f32_dpp v109, v109, v109 row_ror:8 row_mask:0xf bank_mask:0xf
v_mov_b32 v5, v109
v_mfma_f32_16x16x32_bf16 v[16:19], v[52:55], v[116:119], v[16:19]
v_mfma_f32_16x16x32_bf16 v[20:23], v[60:63], v[116:119], v[20:23]
v_permlane16_swap_b32 v109, v5
v_add_f32 v109, v109, v5
v_mfma_f32_16x16x32_bf16 v[24:27], v[64:67], v[112:115], 0
v_mov_b32 v5, v109
v_mfma_f32_16x16x32_bf16 v[24:27], v[68:71], v[116:119], v[24:27]
v_mfma_f32_16x16x32_bf16 v[28:31], v[72:75], v[112:115], 0
v_permlane32_swap_b32 v109, v5
v_add_f32 v109, v109, v5
ds_write_b128 v128, v[16:19] offset:0
v_mfma_f32_16x16x32_bf16 v[28:31], v[76:79], v[116:119], v[28:31]
ds_write_b128 v128, v[20:23] offset:128
ds_write_b64 v129, v[108:109]
s_nop 0
ds_write_b128 v128, v[24:27] offset:256
s_nop 3
ds_write_b128 v128, v[28:31] offset:384
s_waitcnt lgkmcnt(0)
s_barrier
ds_read_b128 v[64:67], v131
ds_read_b128 v[68:71], v131 offset:16
ds_read_b128 v[48:51], v130 offset:0
ds_read_b128 v[52:55], v130 offset:8192
ds_read_b128 v[56:59], v130 offset:16384
ds_read_b128 v[60:63], v130 offset:24576
s_waitcnt lgkmcnt(4)
v_max_f32 v120, v64, v66
v_max3_f32 v120, v120, v68, v70
v_mov_b32 v5, v120
s_nop 1
v_permlane32_swap_b32 v120, v5
v_max_f32 v120, v120, v5
v_sub_f32 v64, v64, v120
v_sub_f32 v66, v66, v120
v_sub_f32 v68, v68, v120
v_sub_f32 v70, v70, v120
v_mul_f32 v64, 0x3fb8aa3b, v64
v_mul_f32 v66, 0x3fb8aa3b, v66
v_mul_f32 v68, 0x3fb8aa3b, v68
v_mul_f32 v70, 0x3fb8aa3b, v70
v_exp_f32 v64, v64
v_exp_f32 v66, v66
v_exp_f32 v68, v68
v_exp_f32 v70, v70
v_mul_f32 v120, 0.5, v120
v_mul_f32 v121, v65, v64
v_fmac_f32 v121, v67, v66
v_fmac_f32 v121, v69, v68
v_fmac_f32 v121, v71, v70
s_waitcnt lgkmcnt(0)
v_pk_mul_f32 v[48:49], v[48:49], v[64:65] op_sel_hi:[1,0]
v_pk_mul_f32 v[50:51], v[50:51], v[64:65] op_sel_hi:[1,0]
v_pk_fma_f32 v[48:49], v[52:53], v[66:67], v[48:49] op_sel_hi:[1,0,1]
v_pk_fma_f32 v[50:51], v[54:55], v[66:67], v[50:51] op_sel_hi:[1,0,1]
v_pk_fma_f32 v[48:49], v[56:57], v[68:69], v[48:49] op_sel_hi:[1,0,1]
v_pk_fma_f32 v[50:51], v[58:59], v[68:69], v[50:51] op_sel_hi:[1,0,1]
v_pk_fma_f32 v[48:49], v[60:61], v[70:71], v[48:49] op_sel_hi:[1,0,1]
v_pk_fma_f32 v[50:51], v[62:63], v[70:71], v[50:51] op_sel_hi:[1,0,1]
s_nop 0
v_permlane32_swap_b32 v48, v120
v_permlane32_swap_b32 v49, v121
v_permlane32_swap_b32 v50, v122
v_permlane32_swap_b32 v51, v123
v_pk_add_f32 v[48:49], v[48:49], v[120:121]
v_pk_add_f32 v[50:51], v[50:51], v[122:123]
v_bfi_b32 v48, v6, s32, v48
v_bfi_b32 v49, v6, s33, v49
v_bfi_b32 v50, v6, s34, v50
v_bfi_b32 v51, v6, s35, v51
s_mov_b32 exec_hi, 1
buffer_store_dwordx4 v[48:51], v132, s[28:31], 0 offen
s_mov_b32 exec_hi, -1
s_and_b32 s60, s3, 5
s_cbranch_scc1 L_G
v_lshlrev_b32 v4, 2, v9
s_mov_b32 s69, 200
P_14:
buffer_load_dwordx4 v[64:67], v135, s[28:31], s57 offen sc1
buffer_load_dwordx4 v[16:19], v134, s[28:31], s56 offen sc1
buffer_load_dwordx4 v[20:23], v134, s[28:31], s56 offen offset:1024 sc1
s_sub_u32 s100, s100, 1
s_cbranch_scc1 L_fin
s_sub_u32 s69, s69, 1
s_cbranch_scc0 P_15
s_add_u32 s56, s56, 819200
s_add_u32 s57, s57, 819200
s_barrier
s_mov_b32 exec_hi, 1
buffer_store_dwordx4 v[48:51], v132, s[28:31], s59 offen sc1
s_mov_b32 exec_hi, -1
P_15:
s_waitcnt vmcnt(0)
v_xor_b32 v5, s32, v64
v_bitop3_b32 v5, v5, v65, s33 bitop3:0xf6
v_bitop3_b32 v5, v5, v66, s34 bitop3:0xf6
v_bitop3_b32 v5, v5, v67, s35 bitop3:0xf6
v_bitop3_b32 v5, v5, v16, s32 bitop3:0xf6
v_bitop3_b32 v5, v5, v17, s33 bitop3:0xf6
v_bitop3_b32 v5, v5, v18, s34 bitop3:0xf6
v_bitop3_b32 v5, v5, v19, s35 bitop3:0xf6
v_bitop3_b32 v5, v5, v20, s32 bitop3:0xf6
v_bitop3_b32 v5, v5, v21, s33 bitop3:0xf6
v_bitop3_b32 v5, v5, v22, s34 bitop3:0xf6
v_bitop3_b32 v5, v5, v23, s35 bitop3:0xf6
v_and_b32 v5, 0xff, v5
v_cmp_ne_u32 vcc, 0, v5
s_cbranch_vccnz P_14
v_and_b32 v64, 0xffffff00, v64
s_nop 1
v_max_f32_dpp v66, v64, v64 row_ror:4 row_mask:0xf bank_mask:0xf
s_nop 1
v_max_f32_dpp v66, v66, v66 row_ror:2 row_mask:0xf bank_mask:0xf
s_nop 1
v_max_f32_dpp v66, v66, v66 row_ror:1 row_mask:0xf bank_mask:0xf
v_sub_f32 v64, v64, v66
v_mul_f32 v64, 0x3fb8aa3b, v64
v_exp_f32 v64, v64
s_nop 0
ds_bpermute_b32 v68, v4, v64
ds_bpermute_b32 v70, v4, v64 offset:16
v_xor_b32 v65, s33, v65
v_xor_b32 v16, s32, v16
v_xor_b32 v17, s33, v17
v_xor_b32 v18, s34, v18
v_xor_b32 v19, s35, v19
v_xor_b32 v20, s32, v20
v_xor_b32 v21, s33, v21
v_xor_b32 v22, s34, v22
v_xor_b32 v23, s35, v23
v_mul_f32 v67, v65, v64
s_nop 1
v_add_f32_dpp v67, v67, v67 row_ror:4 row_mask:0xf bank_mask:0xf
s_nop 1
v_add_f32_dpp v67, v67, v67 row_ror:2 row_mask:0xf bank_mask:0xf
s_nop 1
v_add_f32_dpp v67, v67, v67 row_ror:1 row_mask:0xf bank_mask:0xf
s_waitcnt lgkmcnt(0)
v_pk_mul_f32 v[16:17], v[16:17], v[68:69] op_sel_hi:[1,0]
v_pk_mul_f32 v[18:19], v[18:19], v[68:69] op_sel_hi:[1,0]
v_pk_fma_f32 v[16:17], v[20:21], v[70:71], v[16:17] op_sel_hi:[1,0,1]
v_pk_fma_f32 v[18:19], v[22:23], v[70:71], v[18:19] op_sel_hi:[1,0,1]
s_nop 1
v_permlane32_swap_b32 v16, v18
v_permlane32_swap_b32 v17, v19
v_add_f32 v16, v16, v18
v_add_f32 v17, v17, v19
s_nop 1
v_permlane16_swap_b32 v16, v17
v_add_f32 v16, v16, v17
v_mov_b32 v17, v16
s_nop 1
v_permlane16_swap_b32 v16, v17
v_mov_b32 v18, v16
v_mov_b32 v19, v17
s_nop 0
v_permlane32_swap_b32 v16, v18
v_permlane32_swap_b32 v17, v19
s_mov_b64 exec, 0xff0000
v_mov_b64 v[16:17], v[66:67]
s_mov_b64 exec, 0xffffff
v_bfi_b32 v16, v6, s32, v16
v_bfi_b32 v17, v6, s33, v17
v_bfi_b32 v18, v6, s34, v18
v_bfi_b32 v19, v6, s35, v19
buffer_store_dwordx4 v[16:19], v136, s[28:31], s58 offen sc1
s_mov_b64 exec, -1
s_cmp_lt_i32 s69, 0
s_cbranch_scc1 L_G2
L_G:
s_barrier
s_mov_b32 exec_hi, 1
buffer_store_dwordx4 v[48:51], v132, s[28:31], s59 offen sc1
s_mov_b32 exec_hi, -1
L_G2:
s_cmp_ge_u32 s3, 4
s_cbranch_scc1 L_fin
s_lshl_b32 s56, s41, 2
s_add_u32 s56, s56, s3
s_lshl_b32 s57, s42, 7
s_and_b32 s58, s56, 16
s_lshl_b32 s58, s58, 2
s_add_u32 s57, s57, s58
s_and_b32 s58, s56, 7
s_lshl_b32 s60, s58, 3
s_add_u32 s57, s57, s60
s_bfe_u32 s60, s56, 0x10003
s_lshl_b32 s60, s60, 2
s_add_u32 s57, s57, s60
v_add_lshl_u32 v3, v9, s57, 1
global_load_ushort v40, v3, s[4:5]
s_mov_b32 s52, s22
s_mov_b32 s53, s23
s_mov_b32 s54, 2048
s_mov_b32 s55, 0x20000
buffer_load_ushort v41, v3, s[52:55], 0 offen
s_lshl_b32 s60, s56, 11
s_add_u32 s60, s60, s101
s_add_u32 s61, s60, 1024
s_lshr_b32 s62, s56, 3
s_lshl_b32 s62, s62, 14
s_lshl_b32 s58, s58, 4
s_add_u32 s62, s62, s58
s_add_u32 s62, s62, s101
s_add_u32 s62, s62, 819200
v_mov_b32 v24, 0
v_mov_b32 v25, 0
v_mov_b32 v26, 0
v_mov_b32 v27, 0
s_lshl_b32 s58, s42, 5
s_add_u32 s56, s56, s58
s_lshr_b32 s56, s56, 1
s_and_b32 s58, s3, 1
s_cselect_b32 s56, s56, 0
s_mov_b32 s69, 600
G_16:
buffer_load_dwordx4 v[16:19], v134, s[28:31], s60 offen sc1
s_mov_b32 exec_hi, 0xffffff
buffer_load_dwordx4 v[24:27], v134, s[28:31], s61 offen sc1
s_sub_u32 s100, s100, 1
s_cbranch_scc1 L_fin
s_sub_u32 s69, s69, 1
s_cbranch_scc0 G_17
s_mov_b32 exec_hi, -1
v_lshlrev_b32 v134, 7, v0
s_mov_b32 exec_hi, 0xffffff
s_mov_b32 s60, s62
s_add_u32 s61, s62, 8192
G_17:
s_waitcnt vmcnt(0)
v_xor_b32 v24, s32, v24
v_xor_b32 v25, s33, v25
v_xor_b32 v26, s34, v26
v_xor_b32 v27, s35, v27
s_mov_b32 exec_hi, -1
v_xor_b32 v16, s32, v16
v_xor_b32 v17, s33, v17
v_xor_b32 v18, s34, v18
v_xor_b32 v19, s35, v19
v_or3_b32 v5, v24, v25, v26
v_or3_b32 v4, v27, v16, v17
v_or3_b32 v5, v5, v18, v19
v_bitop3_b32 v5, v5, v4, v6 bitop3:0xa8
v_cmp_ne_u32 vcc, 0, v5
s_cbranch_vccnz G_16
v_permlane32_swap_b32 v16, v24
v_permlane32_swap_b32 v17, v25
v_permlane32_swap_b32 v18, v26
v_permlane32_swap_b32 v19, v27
v_pk_add_f32 v[16:17], v[16:17], v[24:25]
v_pk_add_f32 v[18:19], v[18:19], v[26:27]
v_lshlrev_b32 v40, 16, v40
v_permlane16_swap_b32 v16, v17
v_permlane16_swap_b32 v18, v19
v_add_f32 v16, v16, v17
v_add_f32 v18, v18, v19
s_nop 0
v_add_f32_dpp v16, v16, v16 row_ror:8 row_mask:0xf bank_mask:0xf
v_add_f32_dpp v18, v18, v18 row_ror:8 row_mask:0xf bank_mask:0xf
s_nop 0
v_add_f32_dpp v16, v16, v16 row_ror:4 row_mask:0xf bank_mask:0xf
v_add_f32_dpp v18, v18, v18 row_ror:4 row_mask:0xf bank_mask:0xf
s_nop 0
v_add_f32_dpp v16, v16, v16 row_ror:2 row_mask:0xf bank_mask:0xf
v_add_f32_dpp v18, v18, v18 row_ror:2 row_mask:0xf bank_mask:0xf
s_nop 0
v_add_f32_dpp v16, v16, v16 row_ror:1 row_mask:0xf bank_mask:0xf
v_add_f32_dpp v18, v18, v18 row_ror:1 row_mask:0xf bank_mask:0xf
s_nop 1
v_permlane32_swap_b32 v16, v18
v_cvt_pk_bf16_f32 v16, v18, v16
v_lshlrev_b32 v18, 16, v16
v_and_b32 v16, 0xffff0000, v16
v_mul_f32 v17, 0xbfb8aa3b, v18
v_exp_f32 v17, v17
s_nop 0
v_add_f32 v17, 1.0, v17
v_rcp_f32 v17, v17
s_nop 0
v_mul_f32 v17, v17, v18
v_cvt_pk_bf16_f32 v17, v17, v17
v_and_b32 v17, 0xffff0000, v17
v_mul_f32 v16, v16, v17
v_cvt_pk_bf16_f32 v16, v16, v16
v_and_b32 v16, 0xffff0000, v16
v_add_f32 v16, v16, v40
v_cvt_pk_bf16_f32 v16, v16, v16
s_mov_b32 exec_lo, 0x00010001
s_mov_b32 exec_hi, 0x00010001
buffer_store_short v16, v3, s[52:55], 0 offen
s_cmp_lg_u32 s56, 127
s_cbranch_scc1 L_fin0
s_add_u32 s36, s36, 1
v_mov_b32 v5, s36
s_mov_b64 exec, 1
buffer_store_dword v5, v7, s[28:31], 0 offen
L_fin0:
L_fin:
L_end:
s_endpgm
.p2align 6
.fill 256, 4, 0xbf810000
L_codeend:
.section .rodata,"a"
.p2align 6
.amdhsa_kernel recurrent_scan__sliding_block_cached__glu_gated_glu__decode_kernel
  .amdhsa_next_free_vgpr 188
  .amdhsa_next_free_sgpr 102
  .amdhsa_accum_offset 188
  .amdhsa_group_segment_fixed_size 0
  .amdhsa_kernarg_size 96
  .amdhsa_user_sgpr_count 2
  .amdhsa_user_sgpr_kernarg_segment_ptr 1
  .amdhsa_system_sgpr_workgroup_id_x 1
.end_amdhsa_kernel
```
